```python
import torch

def _softmax(x, axis=-1):
    return torch.softmax(x, dim=axis)
def _gelu(x):
    return torch.nn.functional.gelu(x, approximate="tanh")
def _silu(x):
    return torch.nn.functional.silu(x)
def _sigmoid(x):
    return torch.sigmoid(x)
def _layernorm(x, axis=-1, eps=1e-5):
    m = x.mean(dim=axis, keepdim=True)
    v = x.var(dim=axis, keepdim=True, unbiased=False)
    return (x - m) / torch.sqrt(v + eps)
def _scatter_add(tgt, idx, src, axis=0):
    return tgt.clone().index_add_(axis, idx, src)
def _segment_sum(src, seg, n):
    out = torch.zeros((n,) + src.shape[1:], dtype=src.dtype)
    return out.index_add_(0, seg, src)
def _pad(x, pw):
    flat = tuple(v for pair in reversed(pw) for v in pair)
    return torch.nn.functional.pad(x, flat)

kernel_name = 'parallel_sum__ssm_conv_h3__dense_activation_silu__prompt'

def setup_inputs():

    _w = (lambda a: (lambda t: t.to(torch.bfloat16) if t.is_floating_point() else t)(torch.as_tensor(a)))
    def _A_setup():
        B, S, D = 1, 2048, 1024
        ks = 4
        return {
            "q": _w((lambda *s: torch.randn(*s, dtype=torch.bfloat16) * 0.05)(B, S, D)),
            "k": _w((lambda *s: torch.randn(*s, dtype=torch.bfloat16) * 0.2)(B, S, D)),
            "v": _w((lambda *s: torch.randn(*s, dtype=torch.bfloat16) * 0.2)(B, S, D)),
            "shift_k": _w((lambda *s: torch.randn(*s, dtype=torch.bfloat16) * 0.2)(D, ks) * 0.5),
            "ssm_k": _w((lambda *s: torch.randn(*s, dtype=torch.bfloat16) * 0.4)(D, S) * (1.0 / S ** 0.5)),
            "ssm_D": _w((lambda *s: torch.randn(*s, dtype=torch.bfloat16) * 0.2)(D)),
        }
    _A_in = _A_setup()

    def _B_setup():
        B, S, D, F = 1, 2048, 1024, 3584
        return {
            "x": _w((lambda *s: torch.randn(*s, dtype=torch.bfloat16) * 0.05)(B, S, D)),
            "w1": _w((lambda *s: torch.randn(*s, dtype=torch.bfloat16) * 0.8)(D, F) * (D ** -0.5)),
            "w2": _w((lambda *s: torch.randn(*s, dtype=torch.bfloat16) * 0.1)(F, D) * (F ** -0.5)),
        }
    _B_in = _B_setup()

    return {
        "A_q": _A_in["q"],
        "A_k": _A_in["k"],
        "A_v": _A_in["v"],
        "A_shift_k": _A_in["shift_k"],
        "A_ssm_k": _A_in["ssm_k"],
        "A_ssm_D": _A_in["ssm_D"],
        "B_x": _B_in["x"],
        "B_w1": _B_in["w1"],
        "B_w2": _B_in["w2"],
    }

def reference(A_q, A_k, A_v, A_shift_k, A_ssm_k, A_ssm_D, B_x, B_w1, B_w2):
    def _A_ref(q, k, v, shift_k, ssm_k, ssm_D):
        B, S, D = q.shape
        ks = shift_k.shape[-1]
        k_pad = _pad(k, ((0, 0), (ks - 1, 0), (0, 0)))
        k_shift = torch.zeros_like(k)
        for t in range(ks):
            k_shift = k_shift + k_pad[:, t:t + S, :] * shift_k[:, ks - 1 - t][None, None, :]
        kv = k_shift * v
        L = 2 * S
        kv_pad = _pad(kv, ((0, 0), (0, S), (0, 0)))
        kf_pad = _pad(ssm_k, ((0, 0), (0, S)))
        kv_f = (lambda x, axes=(-2,-1): torch.fft.rfft2(x.float(), dim=axes))(kv_pad[:, None, :, :], axes=(1, 2))
        kf_f = (lambda x, axes=(-2,-1): torch.fft.rfft2(x.float(), dim=axes))(kf_pad[:, None, :], axes=(1, 2))
        kf_f = (lambda x, *d: x.permute(*d))(kf_f, 1, 2, 0)
        y_f = kv_f * kf_f[None, :, :, :]
        y = (lambda x, s, axes=(-2,-1): torch.fft.irfft2(x, s=s, dim=axes).to(torch.bfloat16))(y_f, (1, L), axes=(1, 2))[:, 0, :S, :]
        y = y + kv * ssm_D[None, None, :]
        return q * y

    def _B_ref(x, w1, w2):
        h = torch.einsum("bsd,df->bsf", x, w1)
        h = _silu(h)
        out = torch.einsum("bsf,fd->bsd", h, w2)
        return out

    x = A_q
    xn = _layernorm(x, axis=-1)
    return x + _A_ref(xn, A_k, A_v, A_shift_k, A_ssm_k, A_ssm_D) + _B_ref(xn, B_w1, B_w2)
```

```asm
; @launch grid=(256,1,1) block=(512,1,1) lds=163840
.amdgcn_target "amdgcn-amd-amdhsa--gfx950"
.text
.globl parallel_sum__ssm_conv_h3__dense_activation_silu__prompt_kernel
.p2align 8
.type parallel_sum__ssm_conv_h3__dense_activation_silu__prompt_kernel,@function
parallel_sum__ssm_conv_h3__dense_activation_silu__prompt_kernel:
    s_cmp_ge_u32 s2, 256
    s_cbranch_scc1 L_end
    s_load_dwordx16 s[36:51], s[0:1], 0
    s_load_dwordx8 s[52:59], s[0:1], 64
    s_and_b32 s6, s2, 7
    s_lshr_b32 s7, s2, 3
    s_lshr_b32 s4, s6, 1
    s_lshl_b32 s4, s4, 2
    s_lshr_b32 s5, s7, 3
    s_add_u32 s4, s4, s5
    s_and_b32 s5, s6, 1
    s_lshl_b32 s5, s5, 3
    s_and_b32 s7, s7, 7
    s_add_u32 s5, s5, s7
    s_add_u32 s6, s4, s5
    s_and_b32 s6, s6, 3
    s_and_b32 s7, s4, 12
    s_and_b32 s60, s5, 12
    s_add_u32 s7, s7, s60
    s_and_b32 s7, s7, 12
    s_add_u32 s6, s6, s7
    s_lshl_b32 s6, s6, 4
    s_and_b32 s7, s4, 3
    s_lshl_b32 s7, s7, 3
    s_getpc_b64 s[60:61]
L_pc:
    s_add_u32 s60, s60, L_table - L_pc
    s_addc_u32 s61, s61, 0
    s_load_dwordx2 s[86:87], s[60:61], s6
    s_load_dwordx2 s[88:89], s[60:61], s6 offset:8
    s_mov_b32 s84, s7
    s_and_b32 s6, s5, 7
    s_lshl_b32 s6, s6, 1
    s_lshr_b32 s7, s5, 3
    s_add_u32 s6, s6, s7
    s_lshl_b32 s6, s6, 7
    s_movk_i32 s7, 128
    v_lshrrev_b32 v2, 6, v0
    v_and_b32 v1, 63, v0
    v_readfirstlane_b32 s3, v2
    s_cmp_lt_u32 s3, 4
    s_cbranch_scc1 L_cons
    s_sub_u32 s33, s3, 4
    s_and_b32 s32, s3, 1
    v_lshrrev_b32 v2, 3, v1
    v_lshrrev_b32 v3, 4, v1
    v_xor_b32 v3, v3, v1
    v_and_b32 v3, 7, v3
    v_lshlrev_b32 v3, 4, v3
    v_lshl_add_u32 v3, v2, 11, v3
    s_lshl_b32 s60, s4, 18
    s_lshl_b32 s61, s33, 16
    s_add_u32 s60, s60, s61
    v_add_u32 v4, s60, v3
    v_xor_b32 v3, 64, v4
    v_add_u32 v5, 15360, v3
    v_add_u32 v6, 30720, v4
    v_add_u32 v7, 46080, v3
    s_lshl_b32 s70, s33, 12
    s_mul_i32 s71, s33, 7168
    s_add_u32 s71, s71, 16384
    s_mul_i32 s60, s5, 448
    s_mul_i32 s61, s33, 114688
    s_add_u32 s60, s60, s61
    v_lshl_add_u32 v8, v1, 4, s60
    v_cmp_lt_u32 vcc, 27, v1
    v_add_u32 v2, 6720, v8
    s_mov_b32 s101, 0x00ffffff
    v_cndmask_b32 v8, v8, v2, vcc
    v_xor_b32 v2, 32, v8
    v_add_u32 v9, 13440, v8
    v_add_u32 v10, 26880, v8
    v_add_u32 v11, 40320, v8
    v_add_u32 v12, 57344, v2
    v_add_u32 v13, 70784, v2
    v_add_u32 v14, 84224, v2
    v_add_u32 v15, 97664, v2
    s_mov_b32 s10, 0x400000
    s_mov_b32 s11, 0x20000
    s_mov_b32 s14, 0x700000
    s_mov_b32 s15, 0x20000
    s_waitcnt lgkmcnt(0)
    s_mov_b64 s[8:9], s[36:37]
    s_mov_b64 s[12:13], s[50:51]
    s_bfe_u32 s63, s86, 0x40000
    s_add_u32 m0, s70, 0
    s_lshl_b32 s72, s63, 7
    buffer_load_dwordx4 v4, s[8:11], s72 offen offset:0 lds
    s_mul_i32 s73, s63, 458752
    buffer_load_dwordx4 v5, s[8:11], s72 offen offset:1024 lds
    buffer_load_dwordx4 v6, s[8:11], s72 offen offset:2048 lds
    buffer_load_dwordx4 v7, s[8:11], s72 offen offset:3072 lds
    s_add_u32 m0, s71, 0
    s_mov_b32 exec_hi, s101
    buffer_load_dwordx4 v8, s[12:15], s73 offen offset:0 lds
    buffer_load_dwordx4 v9, s[12:15], s73 offen offset:896 lds
    s_mov_b32 exec_hi, -1
    s_mov_b32 exec_hi, s101
    buffer_load_dwordx4 v10, s[12:15], s73 offen offset:1792 lds
    buffer_load_dwordx4 v11, s[12:15], s73 offen offset:2688 lds
    s_mov_b32 exec_hi, -1
    s_add_u32 m0, s71, 3584
    s_mov_b32 exec_hi, s101
    buffer_load_dwordx4 v12, s[12:15], s73 offen offset:0 lds
    buffer_load_dwordx4 v13, s[12:15], s73 offen offset:896 lds
    s_mov_b32 exec_hi, -1
    s_mov_b32 exec_hi, s101
    buffer_load_dwordx4 v14, s[12:15], s73 offen offset:1792 lds
    buffer_load_dwordx4 v15, s[12:15], s73 offen offset:2688 lds
    s_mov_b32 exec_hi, -1
    s_waitcnt lgkmcnt(0)
    s_add_u32 s28, s58, 0x1900000
    s_addc_u32 s29, s59, 0
    s_mov_b32 s30, 0x10000
    s_mov_b32 s31, 0x20000
    s_load_dwordx2 s[96:97], s[28:29], 0
    s_lshr_b32 s60, s2, 3
    s_lshl_b32 s60, s60, 5
    s_lshl_b32 s61, s33, 3
    s_add_u32 s60, s60, s61
    s_and_b32 s61, s2, 7
    s_add_u32 s68, s60, s61
    s_lshl_b32 s69, s68, 12
    s_lshl_b32 s60, s68, 1
    s_and_b32 s60, s60, 0xfffffffc
    s_load_dword s67, s[46:47], s60
    s_lshl_b32 s60, s2, 2
    s_add_u32 s60, s60, s33
    s_mul_i32 s60, s60, 7168
    s_add_u32 s80, s52, s60
    s_addc_u32 s81, s53, 0
    s_cmp_lt_u32 s3, 6
    s_cbranch_scc1 L_progA
    s_bfe_u32 s63, s86, 0x40004
    s_add_u32 m0, s70, 70656
    s_lshl_b32 s72, s63, 7
    buffer_load_dwordx4 v4, s[8:11], s72 offen offset:0 lds
    s_mul_i32 s73, s63, 458752
    s_lshr_b32 s35, s2, 3
    s_and_b32 s35, s35, 1
    s_add_u32 s20, s58, 0x1000000
    s_addc_u32 s21, s59, 0
    s_mov_b32 s22, 0x400000
    s_mov_b32 s23, 0x20000
    s_mov_b32 s16, s38
    s_mov_b32 s17, s39
    s_mov_b32 s18, 0x400000
    s_mov_b32 s19, 0x20000
    s_mov_b32 s24, s40
    s_mov_b32 s25, s41
    s_mov_b32 s26, 0x400000
    s_mov_b32 s27, 0x20000
    buffer_load_dwordx4 v5, s[8:11], s72 offen offset:1024 lds
    s_mov_b32 s76, s42
    s_mov_b32 s77, s43
    s_mov_b32 s78, 0x2000
    s_mov_b32 s79, 0x20000
    s_and_b32 s75, s2, 7
    s_lshl_b32 s75, s75, 1
    s_lshr_b32 s60, s2, 7
    buffer_load_dwordx4 v6, s[8:11], s72 offen offset:2048 lds
    s_add_u32 s75, s75, s60
    s_bfe_u32 s74, s2, 0x40003
    s_lshl_b32 s60, s75, 4
    s_lshl_b32 s61, s32, 3
    buffer_load_dwordx4 v7, s[8:11], s72 offen offset:3072 lds
    s_add_u32 s60, s60, s61
    v_lshrrev_b32 v2, 3, v1
    v_add_u32 v2, s60, v2
    s_lshl_b32 s62, s74, 3
    s_add_u32 m0, s71, 70656
    s_mov_b32 exec_hi, s101
    buffer_load_dwordx4 v8, s[12:15], s73 offen offset:0 lds
    buffer_load_dwordx4 v9, s[12:15], s73 offen offset:896 lds
    s_mov_b32 exec_hi, -1
    v_and_b32 v3, 7, v1
    v_add_u32 v172, s62, v3
    v_lshlrev_b32 v173, 4, v172
    v_lshl_add_u32 v173, v2, 14, v173
    s_mov_b32 exec_hi, s101
    buffer_load_dwordx4 v10, s[12:15], s73 offen offset:1792 lds
    buffer_load_dwordx4 v11, s[12:15], s73 offen offset:2688 lds
    s_mov_b32 exec_hi, -1
    v_subrev_u32 v174, 6144, v173
    s_movk_i32 s64, 4096
    s_movk_i32 s65, 8192
    s_movk_i32 s66, 12288
    s_add_u32 m0, s71, 74240
    s_mov_b32 exec_hi, s101
    buffer_load_dwordx4 v12, s[12:15], s73 offen offset:0 lds
    buffer_load_dwordx4 v13, s[12:15], s73 offen offset:896 lds
    s_mov_b32 exec_hi, -1
    v_sub_u32 v175, 255, v2
    v_lshlrev_b32 v175, 6, v175
    v_and_b32 v2, 3, v3
    v_lshl_add_u32 v175, v2, 4, v175
    s_mov_b32 exec_hi, s101
    buffer_load_dwordx4 v14, s[12:15], s73 offen offset:1792 lds
    buffer_load_dwordx4 v15, s[12:15], s73 offen offset:2688 lds
    s_mov_b32 exec_hi, -1
    v_lshrrev_b32 v2, 2, v172
    v_lshl_add_u32 v175, v2, 17, v175
    v_lshlrev_b32 v172, 6, v172
    s_cmp_lg_u32 s35, 0
    s_cbranch_scc1 L_kvskip0
    buffer_load_dwordx4 v[16:19], v172, s[76:79], 0 offen offset:0
    buffer_load_dwordx4 v[20:23], v172, s[76:79], 0 offen offset:16
    buffer_load_dwordx4 v[24:27], v172, s[76:79], 0 offen offset:32
    buffer_load_dwordx4 v[28:31], v172, s[76:79], 0 offen offset:48
    buffer_load_dwordx4 v[32:35], v174, s[16:19], 0 offen offset:0 nt
    buffer_load_dwordx4 v[36:39], v174, s[16:19], 0 offen offset:2048 nt
    buffer_load_dwordx4 v[40:43], v174, s[16:19], s64 offen offset:0 nt
    buffer_load_dwordx4 v[44:47], v173, s[16:19], 0 offen offset:0 nt
    buffer_load_dwordx4 v[48:51], v173, s[16:19], 0 offen offset:2048 nt
    buffer_load_dwordx4 v[52:55], v173, s[16:19], s64 offen offset:0 nt
    buffer_load_dwordx4 v[56:59], v173, s[16:19], s64 offen offset:2048 nt
    buffer_load_dwordx4 v[60:63], v173, s[16:19], s65 offen offset:0 nt
    buffer_load_dwordx4 v[64:67], v173, s[16:19], s65 offen offset:2048 nt
    buffer_load_dwordx4 v[68:71], v173, s[16:19], s66 offen offset:0 nt
    buffer_load_dwordx4 v[72:75], v173, s[16:19], s66 offen offset:2048 nt
    buffer_load_dwordx4 v[76:79], v173, s[24:27], 0 offen offset:0 nt
    buffer_load_dwordx4 v[80:83], v173, s[24:27], 0 offen offset:2048 nt
    buffer_load_dwordx4 v[84:87], v173, s[24:27], s64 offen offset:0 nt
    buffer_load_dwordx4 v[88:91], v173, s[24:27], s64 offen offset:2048 nt
    buffer_load_dwordx4 v[92:95], v173, s[24:27], s65 offen offset:0 nt
    buffer_load_dwordx4 v[96:99], v173, s[24:27], s65 offen offset:2048 nt
    buffer_load_dwordx4 v[100:103], v173, s[24:27], s66 offen offset:0 nt
    buffer_load_dwordx4 v[104:107], v173, s[24:27], s66 offen offset:2048 nt
L_kvskip0:
    s_waitcnt lgkmcnt(0)
    s_mul_i32 s94, s96, 0x4c957f2d
    s_mul_hi_u32 s95, s96, 0x4c957f2d
    s_mul_i32 s60, s96, 0x5851f42d
    s_add_u32 s95, s95, s60
    s_mul_i32 s60, s97, 0x4c957f2d
    s_add_u32 s95, s95, s60
    s_add_u32 s94, s94, 0xf767814f
    s_addc_u32 s95, s95, 0x14057b7e
    s_add_u32 s60, s35, 1
    s_cmp_gt_u32 s60, 1
    s_waitcnt vmcnt(35)
    s_cbranch_scc0 L_kvw1
    s_waitcnt vmcnt(12)
L_kvw1:
    s_barrier
    s_bfe_u32 s63, s86, 0x40008
    s_add_u32 m0, s70, 115712
    s_lshl_b32 s72, s63, 7
    buffer_load_dwordx4 v4, s[8:11], s72 offen offset:0 lds
    s_mul_i32 s73, s63, 458752
    s_load_dwordx2 s[82:83], s[80:81], 60
    buffer_load_dwordx4 v5, s[8:11], s72 offen offset:1024 lds
    buffer_load_dwordx4 v6, s[8:11], s72 offen offset:2048 lds
    s_load_dwordx2 s[82:83], s[80:81], 188
    buffer_load_dwordx4 v7, s[8:11], s72 offen offset:3072 lds
    s_add_u32 m0, s71, 115712
    s_mov_b32 exec_hi, s101
    buffer_load_dwordx4 v8, s[12:15], s73 offen offset:0 lds
    buffer_load_dwordx4 v9, s[12:15], s73 offen offset:896 lds
    s_mov_b32 exec_hi, -1
    s_load_dwordx2 s[82:83], s[80:81], 316
    s_mov_b32 exec_hi, s101
    buffer_load_dwordx4 v10, s[12:15], s73 offen offset:1792 lds
    buffer_load_dwordx4 v11, s[12:15], s73 offen offset:2688 lds
    s_mov_b32 exec_hi, -1
    s_add_u32 m0, s71, 119296
    s_mov_b32 exec_hi, s101
    buffer_load_dwordx4 v12, s[12:15], s73 offen offset:0 lds
    buffer_load_dwordx4 v13, s[12:15], s73 offen offset:896 lds
    s_mov_b32 exec_hi, -1
    s_load_dwordx2 s[82:83], s[80:81], 444
    s_mov_b32 exec_hi, s101
    buffer_load_dwordx4 v14, s[12:15], s73 offen offset:1792 lds
    buffer_load_dwordx4 v15, s[12:15], s73 offen offset:2688 lds
    s_mov_b32 exec_hi, -1
    s_cmp_lg_u32 s35, 1
    s_cbranch_scc1 L_kvskip1
    buffer_load_dwordx4 v[16:19], v172, s[76:79], 0 offen offset:0
    buffer_load_dwordx4 v[20:23], v172, s[76:79], 0 offen offset:16
    buffer_load_dwordx4 v[24:27], v172, s[76:79], 0 offen offset:32
    buffer_load_dwordx4 v[28:31], v172, s[76:79], 0 offen offset:48
    buffer_load_dwordx4 v[32:35], v174, s[16:19], 0 offen offset:0 nt
    buffer_load_dwordx4 v[36:39], v174, s[16:19], 0 offen offset:2048 nt
    buffer_load_dwordx4 v[40:43], v174, s[16:19], s64 offen offset:0 nt
    buffer_load_dwordx4 v[44:47], v173, s[16:19], 0 offen offset:0 nt
    buffer_load_dwordx4 v[48:51], v173, s[16:19], 0 offen offset:2048 nt
    buffer_load_dwordx4 v[52:55], v173, s[16:19], s64 offen offset:0 nt
    buffer_load_dwordx4 v[56:59], v173, s[16:19], s64 offen offset:2048 nt
    buffer_load_dwordx4 v[60:63], v173, s[16:19], s65 offen offset:0 nt
    buffer_load_dwordx4 v[64:67], v173, s[16:19], s65 offen offset:2048 nt
    buffer_load_dwordx4 v[68:71], v173, s[16:19], s66 offen offset:0 nt
    buffer_load_dwordx4 v[72:75], v173, s[16:19], s66 offen offset:2048 nt
    buffer_load_dwordx4 v[76:79], v173, s[24:27], 0 offen offset:0 nt
    buffer_load_dwordx4 v[80:83], v173, s[24:27], 0 offen offset:2048 nt
    buffer_load_dwordx4 v[84:87], v173, s[24:27], s64 offen offset:0 nt
    buffer_load_dwordx4 v[88:91], v173, s[24:27], s64 offen offset:2048 nt
    buffer_load_dwordx4 v[92:95], v173, s[24:27], s65 offen offset:0 nt
    buffer_load_dwordx4 v[96:99], v173, s[24:27], s65 offen offset:2048 nt
    buffer_load_dwordx4 v[100:103], v173, s[24:27], s66 offen offset:0 nt
    buffer_load_dwordx4 v[104:107], v173, s[24:27], s66 offen offset:2048 nt
L_kvskip1:
    s_add_u32 s60, s35, 0
    s_cmp_gt_u32 s60, 1
    s_waitcnt vmcnt(35)
    s_cbranch_scc0 L_kvw2
    s_waitcnt vmcnt(12)
L_kvw2:
    s_barrier
    s_bfe_u32 s63, s86, 0x4000c
    s_add_u32 m0, s70, 0
    s_lshl_b32 s72, s63, 7
    buffer_load_dwordx4 v4, s[8:11], s72 offen offset:0 lds
    s_mul_i32 s73, s63, 458752
    s_load_dwordx2 s[82:83], s[80:81], 572
    buffer_load_dwordx4 v5, s[8:11], s72 offen offset:1024 lds
    buffer_load_dwordx4 v6, s[8:11], s72 offen offset:2048 lds
    s_load_dwordx2 s[82:83], s[80:81], 700
    buffer_load_dwordx4 v7, s[8:11], s72 offen offset:3072 lds
    s_add_u32 m0, s71, 0
    s_mov_b32 exec_hi, s101
    buffer_load_dwordx4 v8, s[12:15], s73 offen offset:0 lds
    buffer_load_dwordx4 v9, s[12:15], s73 offen offset:896 lds
    s_mov_b32 exec_hi, -1
    s_load_dwordx2 s[82:83], s[80:81], 828
    s_mov_b32 exec_hi, s101
    buffer_load_dwordx4 v10, s[12:15], s73 offen offset:1792 lds
    buffer_load_dwordx4 v11, s[12:15], s73 offen offset:2688 lds
    s_mov_b32 exec_hi, -1
    s_add_u32 m0, s71, 3584
    s_mov_b32 exec_hi, s101
    buffer_load_dwordx4 v12, s[12:15], s73 offen offset:0 lds
    buffer_load_dwordx4 v13, s[12:15], s73 offen offset:896 lds
    s_mov_b32 exec_hi, -1
    s_load_dwordx2 s[82:83], s[80:81], 956
    s_mov_b32 exec_hi, s101
    buffer_load_dwordx4 v14, s[12:15], s73 offen offset:1792 lds
    buffer_load_dwordx4 v15, s[12:15], s73 offen offset:2688 lds
    s_mov_b32 exec_hi, -1
    s_add_u32 s60, s35, 4294967295
    s_cmp_gt_u32 s60, 1
    s_waitcnt vmcnt(35)
    s_cbranch_scc0 L_kvw3
    s_waitcnt vmcnt(12)
L_kvw3:
    s_barrier
    s_bfe_u32 s63, s86, 0x40010
    s_add_u32 m0, s70, 70656
    s_lshl_b32 s72, s63, 7
    buffer_load_dwordx4 v4, s[8:11], s72 offen offset:0 lds
    s_mul_i32 s73, s63, 458752
    s_load_dwordx2 s[82:83], s[80:81], 1084
    s_load_dwordx2 s[82:83], s[80:81], 1212
    s_load_dwordx2 s[82:83], s[80:81], 1340
    s_load_dwordx2 s[82:83], s[80:81], 1468
    s_waitcnt vmcnt(13)
    v_lshlrev_b32 v108, 16, v16
    v_lshlrev_b32 v109, 16, v18
    v_and_b32 v110, 0xffff0000, v16
    v_and_b32 v111, 0xffff0000, v18
    v_lshlrev_b32 v112, 16, v17
    v_lshlrev_b32 v113, 16, v19
    buffer_load_dwordx4 v5, s[8:11], s72 offen offset:1024 lds
    v_and_b32 v114, 0xffff0000, v17
    v_and_b32 v115, 0xffff0000, v19
    v_lshlrev_b32 v116, 16, v32
    v_and_b32 v117, 0xffff0000, v32
    v_lshlrev_b32 v118, 16, v36
    v_and_b32 v119, 0xffff0000, v36
    v_lshlrev_b32 v120, 16, v40
    v_and_b32 v121, 0xffff0000, v40
    v_lshlrev_b32 v122, 16, v44
    v_and_b32 v123, 0xffff0000, v44
    buffer_load_dwordx4 v6, s[8:11], s72 offen offset:2048 lds
    v_lshlrev_b32 v124, 16, v48
    v_and_b32 v125, 0xffff0000, v48
    v_lshlrev_b32 v126, 16, v52
    v_and_b32 v127, 0xffff0000, v52
    v_lshlrev_b32 v128, 16, v56
    v_and_b32 v129, 0xffff0000, v56
    v_lshlrev_b32 v130, 16, v60
    v_and_b32 v131, 0xffff0000, v60
    v_lshlrev_b32 v132, 16, v64
    v_and_b32 v133, 0xffff0000, v64
    buffer_load_dwordx4 v7, s[8:11], s72 offen offset:3072 lds
    v_lshlrev_b32 v134, 16, v68
    v_and_b32 v135, 0xffff0000, v68
    v_lshlrev_b32 v136, 16, v72
    v_and_b32 v137, 0xffff0000, v72
    v_lshlrev_b32 v138, 16, v76
    v_and_b32 v139, 0xffff0000, v76
    v_lshlrev_b32 v140, 16, v80
    v_and_b32 v141, 0xffff0000, v80
    v_lshlrev_b32 v142, 16, v84
    v_and_b32 v143, 0xffff0000, v84
    s_add_u32 m0, s71, 70656
    s_mov_b32 exec_hi, s101
    buffer_load_dwordx4 v8, s[12:15], s73 offen offset:0 lds
    buffer_load_dwordx4 v9, s[12:15], s73 offen offset:896 lds
    s_mov_b32 exec_hi, -1
    v_lshlrev_b32 v144, 16, v88
    v_and_b32 v145, 0xffff0000, v88
    v_lshlrev_b32 v146, 16, v92
    v_and_b32 v147, 0xffff0000, v92
    v_lshlrev_b32 v148, 16, v96
    v_and_b32 v149, 0xffff0000, v96
    v_lshlrev_b32 v150, 16, v100
    v_and_b32 v151, 0xffff0000, v100
    v_lshlrev_b32 v152, 16, v104
    v_and_b32 v153, 0xffff0000, v104
    v_mul_f32 v176, v116, v114
    s_mov_b32 exec_hi, s101
    buffer_load_dwordx4 v10, s[12:15], s73 offen offset:1792 lds
    buffer_load_dwordx4 v11, s[12:15], s73 offen offset:2688 lds
    s_mov_b32 exec_hi, -1
    v_mul_f32 v177, v117, v115
    v_fmac_f32 v176, v118, v112
    v_fmac_f32 v177, v119, v113
    v_fmac_f32 v176, v120, v110
    v_fmac_f32 v177, v121, v111
    v_fmac_f32 v176, v122, v108
    v_fmac_f32 v177, v123, v109
    v_mul_f32 v138, v176, v138
    v_mul_f32 v139, v177, v139
    v_mul_f32 v178, v118, v114
    s_add_u32 m0, s71, 74240
    s_mov_b32 exec_hi, s101
    buffer_load_dwordx4 v12, s[12:15], s73 offen offset:0 lds
    buffer_load_dwordx4 v13, s[12:15], s73 offen offset:896 lds
    s_mov_b32 exec_hi, -1
    v_mul_f32 v179, v119, v115
    v_fmac_f32 v178, v120, v112
    v_fmac_f32 v179, v121, v113
    v_fmac_f32 v178, v122, v110
    v_fmac_f32 v179, v123, v111
    v_fmac_f32 v178, v124, v108
    v_fmac_f32 v179, v125, v109
    v_mul_f32 v140, v178, v140
    v_mul_f32 v141, v179, v141
    v_mul_f32 v176, v120, v114
    s_mov_b32 exec_hi, s101
    buffer_load_dwordx4 v14, s[12:15], s73 offen offset:1792 lds
    buffer_load_dwordx4 v15, s[12:15], s73 offen offset:2688 lds
    s_mov_b32 exec_hi, -1
    v_mul_f32 v177, v121, v115
    v_fmac_f32 v176, v122, v112
    v_fmac_f32 v177, v123, v113
    v_fmac_f32 v176, v124, v110
    v_fmac_f32 v177, v125, v111
    v_fmac_f32 v176, v126, v108
    v_fmac_f32 v177, v127, v109
    v_mul_f32 v142, v176, v142
    v_mul_f32 v143, v177, v143
    v_mul_f32 v178, v122, v114
    s_waitcnt vmcnt(12)
    s_barrier
    s_bfe_u32 s63, s86, 0x40014
    s_add_u32 m0, s70, 115712
    s_lshl_b32 s72, s63, 7
    buffer_load_dwordx4 v4, s[8:11], s72 offen offset:0 lds
    s_mul_i32 s73, s63, 458752
    s_load_dwordx2 s[82:83], s[80:81], 1596
    s_load_dwordx2 s[82:83], s[80:81], 1724
    s_load_dwordx2 s[82:83], s[80:81], 1852
    s_load_dwordx2 s[82:83], s[80:81], 1980
    v_mul_f32 v179, v123, v115
    v_fmac_f32 v178, v124, v112
    v_fmac_f32 v179, v125, v113
    v_fmac_f32 v178, v126, v110
    v_fmac_f32 v179, v127, v111
    v_fmac_f32 v178, v128, v108
    v_fmac_f32 v179, v129, v109
    buffer_load_dwordx4 v5, s[8:11], s72 offen offset:1024 lds
    v_mul_f32 v144, v178, v144
    v_mul_f32 v145, v179, v145
    v_mul_f32 v176, v124, v114
    v_mul_f32 v177, v125, v115
    v_fmac_f32 v176, v126, v112
    v_fmac_f32 v177, v127, v113
    v_fmac_f32 v176, v128, v110
    v_fmac_f32 v177, v129, v111
    v_fmac_f32 v176, v130, v108
    v_fmac_f32 v177, v131, v109
    buffer_load_dwordx4 v6, s[8:11], s72 offen offset:2048 lds
    v_mul_f32 v146, v176, v146
    v_mul_f32 v147, v177, v147
    v_mul_f32 v178, v126, v114
    v_mul_f32 v179, v127, v115
    v_fmac_f32 v178, v128, v112
    v_fmac_f32 v179, v129, v113
    v_fmac_f32 v178, v130, v110
    v_fmac_f32 v179, v131, v111
    v_fmac_f32 v178, v132, v108
    v_fmac_f32 v179, v133, v109
    buffer_load_dwordx4 v7, s[8:11], s72 offen offset:3072 lds
    v_mul_f32 v148, v178, v148
    v_mul_f32 v149, v179, v149
    v_mul_f32 v176, v128, v114
    v_mul_f32 v177, v129, v115
    v_fmac_f32 v176, v130, v112
    v_fmac_f32 v177, v131, v113
    v_fmac_f32 v176, v132, v110
    v_fmac_f32 v177, v133, v111
    v_fmac_f32 v176, v134, v108
    v_fmac_f32 v177, v135, v109
    s_add_u32 m0, s71, 115712
    s_mov_b32 exec_hi, s101
    buffer_load_dwordx4 v8, s[12:15], s73 offen offset:0 lds
    buffer_load_dwordx4 v9, s[12:15], s73 offen offset:896 lds
    s_mov_b32 exec_hi, -1
    v_mul_f32 v150, v176, v150
    v_mul_f32 v151, v177, v151
    v_mul_f32 v178, v130, v114
    v_mul_f32 v179, v131, v115
    v_fmac_f32 v178, v132, v112
    v_fmac_f32 v179, v133, v113
    v_fmac_f32 v178, v134, v110
    v_fmac_f32 v179, v135, v111
    v_fmac_f32 v178, v136, v108
    v_fmac_f32 v179, v137, v109
    v_mul_f32 v152, v178, v152
    s_mov_b32 exec_hi, s101
    buffer_load_dwordx4 v10, s[12:15], s73 offen offset:1792 lds
    buffer_load_dwordx4 v11, s[12:15], s73 offen offset:2688 lds
    s_mov_b32 exec_hi, -1
    v_mul_f32 v153, v179, v153
    v_cvt_pk_bf16_f32 v154, v152, v150
    v_cvt_pk_bf16_f32 v155, v148, v146
    v_cvt_pk_bf16_f32 v156, v144, v142
    v_cvt_pk_bf16_f32 v157, v140, v138
    v_cvt_pk_bf16_f32 v158, v153, v151
    v_cvt_pk_bf16_f32 v159, v149, v147
    v_cvt_pk_bf16_f32 v160, v145, v143
    v_cvt_pk_bf16_f32 v161, v141, v139
    s_mov_b32 s60, 0
    buffer_store_dwordx4 v[154:157], v175, s[20:23], s60 offen sc1
    s_add_u32 m0, s71, 119296
    s_mov_b32 exec_hi, s101
    buffer_load_dwordx4 v12, s[12:15], s73 offen offset:0 lds
    buffer_load_dwordx4 v13, s[12:15], s73 offen offset:896 lds
    s_mov_b32 exec_hi, -1
    s_mov_b32 s60, 16384
    buffer_store_dwordx4 v[158:161], v175, s[20:23], s60 offen sc1
    v_lshlrev_b32 v108, 16, v20
    v_lshlrev_b32 v109, 16, v22
    v_and_b32 v110, 0xffff0000, v20
    v_and_b32 v111, 0xffff0000, v22
    v_lshlrev_b32 v112, 16, v21
    v_lshlrev_b32 v113, 16, v23
    v_and_b32 v114, 0xffff0000, v21
    v_and_b32 v115, 0xffff0000, v23
    v_lshlrev_b32 v116, 16, v33
    s_mov_b32 exec_hi, s101
    buffer_load_dwordx4 v14, s[12:15], s73 offen offset:1792 lds
    buffer_load_dwordx4 v15, s[12:15], s73 offen offset:2688 lds
    s_mov_b32 exec_hi, -1
    v_and_b32 v117, 0xffff0000, v33
    v_lshlrev_b32 v118, 16, v37
    v_and_b32 v119, 0xffff0000, v37
    v_lshlrev_b32 v120, 16, v41
    v_and_b32 v121, 0xffff0000, v41
    v_lshlrev_b32 v122, 16, v45
    v_and_b32 v123, 0xffff0000, v45
    v_lshlrev_b32 v124, 16, v49
    v_and_b32 v125, 0xffff0000, v49
    v_lshlrev_b32 v126, 16, v53
    s_waitcnt vmcnt(14)
    s_barrier
    s_bfe_u32 s63, s86, 0x40018
    s_add_u32 m0, s70, 0
    s_lshl_b32 s72, s63, 7
    buffer_load_dwordx4 v4, s[8:11], s72 offen offset:0 lds
    s_mul_i32 s73, s63, 458752
    s_load_dwordx2 s[82:83], s[80:81], 2108
    s_load_dwordx2 s[82:83], s[80:81], 2236
    s_load_dwordx2 s[82:83], s[80:81], 2364
    s_load_dwordx2 s[82:83], s[80:81], 2492
    v_and_b32 v127, 0xffff0000, v53
    v_lshlrev_b32 v128, 16, v57
    v_and_b32 v129, 0xffff0000, v57
    v_lshlrev_b32 v130, 16, v61
    v_and_b32 v131, 0xffff0000, v61
    v_lshlrev_b32 v132, 16, v65
    v_and_b32 v133, 0xffff0000, v65
    buffer_load_dwordx4 v5, s[8:11], s72 offen offset:1024 lds
    v_lshlrev_b32 v134, 16, v69
    v_and_b32 v135, 0xffff0000, v69
    v_lshlrev_b32 v136, 16, v73
    v_and_b32 v137, 0xffff0000, v73
    v_lshlrev_b32 v138, 16, v77
    v_and_b32 v139, 0xffff0000, v77
    v_lshlrev_b32 v140, 16, v81
    v_and_b32 v141, 0xffff0000, v81
    v_lshlrev_b32 v142, 16, v85
    v_and_b32 v143, 0xffff0000, v85
    buffer_load_dwordx4 v6, s[8:11], s72 offen offset:2048 lds
    v_lshlrev_b32 v144, 16, v89
    v_and_b32 v145, 0xffff0000, v89
    v_lshlrev_b32 v146, 16, v93
    v_and_b32 v147, 0xffff0000, v93
    v_lshlrev_b32 v148, 16, v97
    v_and_b32 v149, 0xffff0000, v97
    v_lshlrev_b32 v150, 16, v101
    v_and_b32 v151, 0xffff0000, v101
    v_lshlrev_b32 v152, 16, v105
    v_and_b32 v153, 0xffff0000, v105
    buffer_load_dwordx4 v7, s[8:11], s72 offen offset:3072 lds
    v_mul_f32 v176, v116, v114
    v_mul_f32 v177, v117, v115
    v_fmac_f32 v176, v118, v112
    v_fmac_f32 v177, v119, v113
    v_fmac_f32 v176, v120, v110
    v_fmac_f32 v177, v121, v111
    v_fmac_f32 v176, v122, v108
    v_fmac_f32 v177, v123, v109
    v_mul_f32 v138, v176, v138
    v_mul_f32 v139, v177, v139
    s_add_u32 m0, s71, 0
    s_mov_b32 exec_hi, s101
    buffer_load_dwordx4 v8, s[12:15], s73 offen offset:0 lds
    buffer_load_dwordx4 v9, s[12:15], s73 offen offset:896 lds
    s_mov_b32 exec_hi, -1
    v_mul_f32 v178, v118, v114
    v_mul_f32 v179, v119, v115
    v_fmac_f32 v178, v120, v112
    v_fmac_f32 v179, v121, v113
    v_fmac_f32 v178, v122, v110
    v_fmac_f32 v179, v123, v111
    v_fmac_f32 v178, v124, v108
    v_fmac_f32 v179, v125, v109
    v_mul_f32 v140, v178, v140
    v_mul_f32 v141, v179, v141
    v_mul_f32 v176, v120, v114
    s_mov_b32 exec_hi, s101
    buffer_load_dwordx4 v10, s[12:15], s73 offen offset:1792 lds
    buffer_load_dwordx4 v11, s[12:15], s73 offen offset:2688 lds
    s_mov_b32 exec_hi, -1
    v_mul_f32 v177, v121, v115
    v_fmac_f32 v176, v122, v112
    v_fmac_f32 v177, v123, v113
    v_fmac_f32 v176, v124, v110
    v_fmac_f32 v177, v125, v111
    v_fmac_f32 v176, v126, v108
    v_fmac_f32 v177, v127, v109
    v_mul_f32 v142, v176, v142
    v_mul_f32 v143, v177, v143
    v_mul_f32 v178, v122, v114
    s_add_u32 m0, s71, 3584
    s_mov_b32 exec_hi, s101
    buffer_load_dwordx4 v12, s[12:15], s73 offen offset:0 lds
    buffer_load_dwordx4 v13, s[12:15], s73 offen offset:896 lds
    s_mov_b32 exec_hi, -1
    v_mul_f32 v179, v123, v115
    v_fmac_f32 v178, v124, v112
    v_fmac_f32 v179, v125, v113
    v_fmac_f32 v178, v126, v110
    v_fmac_f32 v179, v127, v111
    v_fmac_f32 v178, v128, v108
    v_fmac_f32 v179, v129, v109
    v_mul_f32 v144, v178, v144
    v_mul_f32 v145, v179, v145
    v_mul_f32 v176, v124, v114
    s_mov_b32 exec_hi, s101
    buffer_load_dwordx4 v14, s[12:15], s73 offen offset:1792 lds
    buffer_load_dwordx4 v15, s[12:15], s73 offen offset:2688 lds
    s_mov_b32 exec_hi, -1
    v_mul_f32 v177, v125, v115
    v_fmac_f32 v176, v126, v112
    v_fmac_f32 v177, v127, v113
    v_fmac_f32 v176, v128, v110
    v_fmac_f32 v177, v129, v111
    v_fmac_f32 v176, v130, v108
    v_fmac_f32 v177, v131, v109
    v_mul_f32 v146, v176, v146
    v_mul_f32 v147, v177, v147
    v_mul_f32 v178, v126, v114
    s_waitcnt vmcnt(12)
    s_barrier
    s_bfe_u32 s63, s86, 0x4001c
    s_add_u32 m0, s70, 70656
    s_lshl_b32 s72, s63, 7
    buffer_load_dwordx4 v4, s[8:11], s72 offen offset:0 lds
    s_mul_i32 s73, s63, 458752
    s_load_dwordx2 s[82:83], s[80:81], 2620
    s_load_dwordx2 s[82:83], s[80:81], 2748
    s_load_dwordx2 s[82:83], s[80:81], 2876
    s_load_dwordx2 s[82:83], s[80:81], 3004
    v_mul_f32 v179, v127, v115
    v_fmac_f32 v178, v128, v112
    v_fmac_f32 v179, v129, v113
    v_fmac_f32 v178, v130, v110
    v_fmac_f32 v179, v131, v111
    v_fmac_f32 v178, v132, v108
    v_fmac_f32 v179, v133, v109
    buffer_load_dwordx4 v5, s[8:11], s72 offen offset:1024 lds
    v_mul_f32 v148, v178, v148
    v_mul_f32 v149, v179, v149
    v_mul_f32 v176, v128, v114
    v_mul_f32 v177, v129, v115
    v_fmac_f32 v176, v130, v112
    v_fmac_f32 v177, v131, v113
    v_fmac_f32 v176, v132, v110
    v_fmac_f32 v177, v133, v111
    v_fmac_f32 v176, v134, v108
    v_fmac_f32 v177, v135, v109
    buffer_load_dwordx4 v6, s[8:11], s72 offen offset:2048 lds
    v_mul_f32 v150, v176, v150
    v_mul_f32 v151, v177, v151
    v_mul_f32 v178, v130, v114
    v_mul_f32 v179, v131, v115
    v_fmac_f32 v178, v132, v112
    v_fmac_f32 v179, v133, v113
    v_fmac_f32 v178, v134, v110
    v_fmac_f32 v179, v135, v111
    v_fmac_f32 v178, v136, v108
    v_fmac_f32 v179, v137, v109
    buffer_load_dwordx4 v7, s[8:11], s72 offen offset:3072 lds
    v_mul_f32 v152, v178, v152
    v_mul_f32 v153, v179, v153
    v_cvt_pk_bf16_f32 v162, v152, v150
    v_cvt_pk_bf16_f32 v163, v148, v146
    v_cvt_pk_bf16_f32 v164, v144, v142
    v_cvt_pk_bf16_f32 v165, v140, v138
    v_cvt_pk_bf16_f32 v166, v153, v151
    v_cvt_pk_bf16_f32 v167, v149, v147
    v_cvt_pk_bf16_f32 v168, v145, v143
    v_cvt_pk_bf16_f32 v169, v141, v139
    s_add_u32 m0, s71, 70656
    s_mov_b32 exec_hi, s101
    buffer_load_dwordx4 v8, s[12:15], s73 offen offset:0 lds
    buffer_load_dwordx4 v9, s[12:15], s73 offen offset:896 lds
    s_mov_b32 exec_hi, -1
    s_mov_b32 s60, 32768
    buffer_store_dwordx4 v[162:165], v175, s[20:23], s60 offen sc1
    s_mov_b32 s60, 49152
    buffer_store_dwordx4 v[166:169], v175, s[20:23], s60 offen sc1
    v_lshlrev_b32 v108, 16, v24
    v_lshlrev_b32 v109, 16, v26
    v_and_b32 v110, 0xffff0000, v24
    v_and_b32 v111, 0xffff0000, v26
    v_lshlrev_b32 v112, 16, v25
    v_lshlrev_b32 v113, 16, v27
    v_and_b32 v114, 0xffff0000, v25
    v_and_b32 v115, 0xffff0000, v27
    v_lshlrev_b32 v116, 16, v34
    s_mov_b32 exec_hi, s101
    buffer_load_dwordx4 v10, s[12:15], s73 offen offset:1792 lds
    buffer_load_dwordx4 v11, s[12:15], s73 offen offset:2688 lds
    s_mov_b32 exec_hi, -1
    v_and_b32 v117, 0xffff0000, v34
    v_lshlrev_b32 v118, 16, v38
    v_and_b32 v119, 0xffff0000, v38
    v_lshlrev_b32 v120, 16, v42
    v_and_b32 v121, 0xffff0000, v42
    v_lshlrev_b32 v122, 16, v46
    v_and_b32 v123, 0xffff0000, v46
    v_lshlrev_b32 v124, 16, v50
    v_and_b32 v125, 0xffff0000, v50
    v_lshlrev_b32 v126, 16, v54
    s_add_u32 m0, s71, 74240
    s_mov_b32 exec_hi, s101
    buffer_load_dwordx4 v12, s[12:15], s73 offen offset:0 lds
    buffer_load_dwordx4 v13, s[12:15], s73 offen offset:896 lds
    s_mov_b32 exec_hi, -1
    v_and_b32 v127, 0xffff0000, v54
    v_lshlrev_b32 v128, 16, v58
    v_and_b32 v129, 0xffff0000, v58
    v_lshlrev_b32 v130, 16, v62
    v_and_b32 v131, 0xffff0000, v62
    v_lshlrev_b32 v132, 16, v66
    v_and_b32 v133, 0xffff0000, v66
    v_lshlrev_b32 v134, 16, v70
    v_and_b32 v135, 0xffff0000, v70
    v_lshlrev_b32 v136, 16, v74
    s_mov_b32 exec_hi, s101
    buffer_load_dwordx4 v14, s[12:15], s73 offen offset:1792 lds
    buffer_load_dwordx4 v15, s[12:15], s73 offen offset:2688 lds
    s_mov_b32 exec_hi, -1
    v_and_b32 v137, 0xffff0000, v74
    v_lshlrev_b32 v138, 16, v78
    v_and_b32 v139, 0xffff0000, v78
    v_lshlrev_b32 v140, 16, v82
    v_and_b32 v141, 0xffff0000, v82
    v_lshlrev_b32 v142, 16, v86
    v_and_b32 v143, 0xffff0000, v86
    v_lshlrev_b32 v144, 16, v90
    v_and_b32 v145, 0xffff0000, v90
    v_lshlrev_b32 v146, 16, v94
    s_waitcnt vmcnt(14)
    s_barrier
    s_bfe_u32 s63, s87, 0x40000
    s_add_u32 m0, s70, 115712
    s_lshl_b32 s72, s63, 7
    buffer_load_dwordx4 v4, s[8:11], s72 offen offset:0 lds
    s_mul_i32 s73, s63, 458752
    s_load_dwordx2 s[82:83], s[80:81], 3132
    s_load_dwordx2 s[82:83], s[80:81], 3260
    s_load_dwordx2 s[82:83], s[80:81], 3388
    s_load_dwordx2 s[82:83], s[80:81], 3516
    v_and_b32 v147, 0xffff0000, v94
    v_lshlrev_b32 v148, 16, v98
    v_and_b32 v149, 0xffff0000, v98
    v_lshlrev_b32 v150, 16, v102
    v_and_b32 v151, 0xffff0000, v102
    v_lshlrev_b32 v152, 16, v106
    v_and_b32 v153, 0xffff0000, v106
    buffer_load_dwordx4 v5, s[8:11], s72 offen offset:1024 lds
    v_mul_f32 v176, v116, v114
    v_mul_f32 v177, v117, v115
    v_fmac_f32 v176, v118, v112
    v_fmac_f32 v177, v119, v113
    v_fmac_f32 v176, v120, v110
    v_fmac_f32 v177, v121, v111
    v_fmac_f32 v176, v122, v108
    v_fmac_f32 v177, v123, v109
    v_mul_f32 v138, v176, v138
    v_mul_f32 v139, v177, v139
    buffer_load_dwordx4 v6, s[8:11], s72 offen offset:2048 lds
    v_mul_f32 v178, v118, v114
    v_mul_f32 v179, v119, v115
    v_fmac_f32 v178, v120, v112
    v_fmac_f32 v179, v121, v113
    v_fmac_f32 v178, v122, v110
    v_fmac_f32 v179, v123, v111
    v_fmac_f32 v178, v124, v108
    v_fmac_f32 v179, v125, v109
    v_mul_f32 v140, v178, v140
    v_mul_f32 v141, v179, v141
    buffer_load_dwordx4 v7, s[8:11], s72 offen offset:3072 lds
    v_mul_f32 v176, v120, v114
    v_mul_f32 v177, v121, v115
    v_fmac_f32 v176, v122, v112
    v_fmac_f32 v177, v123, v113
    v_fmac_f32 v176, v124, v110
    v_fmac_f32 v177, v125, v111
    v_fmac_f32 v176, v126, v108
    v_fmac_f32 v177, v127, v109
    v_mul_f32 v142, v176, v142
    v_mul_f32 v143, v177, v143
    s_add_u32 m0, s71, 115712
    s_mov_b32 exec_hi, s101
    buffer_load_dwordx4 v8, s[12:15], s73 offen offset:0 lds
    buffer_load_dwordx4 v9, s[12:15], s73 offen offset:896 lds
    s_mov_b32 exec_hi, -1
    v_mul_f32 v178, v122, v114
    v_mul_f32 v179, v123, v115
    v_fmac_f32 v178, v124, v112
    v_fmac_f32 v179, v125, v113
    v_fmac_f32 v178, v126, v110
    v_fmac_f32 v179, v127, v111
    v_fmac_f32 v178, v128, v108
    v_fmac_f32 v179, v129, v109
    v_mul_f32 v144, v178, v144
    v_mul_f32 v145, v179, v145
    v_mul_f32 v176, v124, v114
    s_mov_b32 exec_hi, s101
    buffer_load_dwordx4 v10, s[12:15], s73 offen offset:1792 lds
    buffer_load_dwordx4 v11, s[12:15], s73 offen offset:2688 lds
    s_mov_b32 exec_hi, -1
    v_mul_f32 v177, v125, v115
    v_fmac_f32 v176, v126, v112
    v_fmac_f32 v177, v127, v113
    v_fmac_f32 v176, v128, v110
    v_fmac_f32 v177, v129, v111
    v_fmac_f32 v176, v130, v108
    v_fmac_f32 v177, v131, v109
    v_mul_f32 v146, v176, v146
    v_mul_f32 v147, v177, v147
    v_mul_f32 v178, v126, v114
    s_add_u32 m0, s71, 119296
    s_mov_b32 exec_hi, s101
    buffer_load_dwordx4 v12, s[12:15], s73 offen offset:0 lds
    buffer_load_dwordx4 v13, s[12:15], s73 offen offset:896 lds
    s_mov_b32 exec_hi, -1
    v_mul_f32 v179, v127, v115
    v_fmac_f32 v178, v128, v112
    v_fmac_f32 v179, v129, v113
    v_fmac_f32 v178, v130, v110
    v_fmac_f32 v179, v131, v111
    v_fmac_f32 v178, v132, v108
    v_fmac_f32 v179, v133, v109
    v_mul_f32 v148, v178, v148
    v_mul_f32 v149, v179, v149
    v_mul_f32 v176, v128, v114
    s_mov_b32 exec_hi, s101
    buffer_load_dwordx4 v14, s[12:15], s73 offen offset:1792 lds
    buffer_load_dwordx4 v15, s[12:15], s73 offen offset:2688 lds
    s_mov_b32 exec_hi, -1
    v_mul_f32 v177, v129, v115
    v_fmac_f32 v176, v130, v112
    v_fmac_f32 v177, v131, v113
    v_fmac_f32 v176, v132, v110
    v_fmac_f32 v177, v133, v111
    v_fmac_f32 v176, v134, v108
    v_fmac_f32 v177, v135, v109
    v_mul_f32 v150, v176, v150
    v_mul_f32 v151, v177, v151
    v_mul_f32 v178, v130, v114
    s_waitcnt vmcnt(12)
    s_barrier
    s_bfe_u32 s63, s87, 0x40004
    s_add_u32 m0, s70, 0
    s_lshl_b32 s72, s63, 7
    buffer_load_dwordx4 v4, s[8:11], s72 offen offset:0 lds
    s_mul_i32 s73, s63, 458752
    s_load_dwordx2 s[82:83], s[80:81], 3644
    s_load_dwordx2 s[82:83], s[80:81], 3772
    s_load_dwordx2 s[82:83], s[80:81], 3900
    s_load_dwordx2 s[82:83], s[80:81], 4028
    v_mul_f32 v179, v131, v115
    v_fmac_f32 v178, v132, v112
    v_fmac_f32 v179, v133, v113
    v_fmac_f32 v178, v134, v110
    v_fmac_f32 v179, v135, v111
    v_fmac_f32 v178, v136, v108
    v_fmac_f32 v179, v137, v109
    buffer_load_dwordx4 v5, s[8:11], s72 offen offset:1024 lds
    v_mul_f32 v152, v178, v152
    v_mul_f32 v153, v179, v153
    v_cvt_pk_bf16_f32 v154, v152, v150
    v_cvt_pk_bf16_f32 v155, v148, v146
    v_cvt_pk_bf16_f32 v156, v144, v142
    v_cvt_pk_bf16_f32 v157, v140, v138
    v_cvt_pk_bf16_f32 v158, v153, v151
    v_cvt_pk_bf16_f32 v159, v149, v147
    v_cvt_pk_bf16_f32 v160, v145, v143
    v_cvt_pk_bf16_f32 v161, v141, v139
    buffer_load_dwordx4 v6, s[8:11], s72 offen offset:2048 lds
    s_mov_b32 s60, 65536
    buffer_store_dwordx4 v[154:157], v175, s[20:23], s60 offen sc1
    s_mov_b32 s60, 81920
    buffer_store_dwordx4 v[158:161], v175, s[20:23], s60 offen sc1
    v_lshlrev_b32 v108, 16, v28
    v_lshlrev_b32 v109, 16, v30
    v_and_b32 v110, 0xffff0000, v28
    v_and_b32 v111, 0xffff0000, v30
    v_lshlrev_b32 v112, 16, v29
    v_lshlrev_b32 v113, 16, v31
    v_and_b32 v114, 0xffff0000, v29
    v_and_b32 v115, 0xffff0000, v31
    buffer_load_dwordx4 v7, s[8:11], s72 offen offset:3072 lds
    v_lshlrev_b32 v116, 16, v35
    v_and_b32 v117, 0xffff0000, v35
    v_lshlrev_b32 v118, 16, v39
    v_and_b32 v119, 0xffff0000, v39
    v_lshlrev_b32 v120, 16, v43
    v_and_b32 v121, 0xffff0000, v43
    v_lshlrev_b32 v122, 16, v47
    v_and_b32 v123, 0xffff0000, v47
    v_lshlrev_b32 v124, 16, v51
    v_and_b32 v125, 0xffff0000, v51
    s_add_u32 m0, s71, 0
    s_mov_b32 exec_hi, s101
    buffer_load_dwordx4 v8, s[12:15], s73 offen offset:0 lds
    buffer_load_dwordx4 v9, s[12:15], s73 offen offset:896 lds
    s_mov_b32 exec_hi, -1
    v_lshlrev_b32 v126, 16, v55
    v_and_b32 v127, 0xffff0000, v55
    v_lshlrev_b32 v128, 16, v59
    v_and_b32 v129, 0xffff0000, v59
    v_lshlrev_b32 v130, 16, v63
    v_and_b32 v131, 0xffff0000, v63
    v_lshlrev_b32 v132, 16, v67
    v_and_b32 v133, 0xffff0000, v67
    v_lshlrev_b32 v134, 16, v71
    v_and_b32 v135, 0xffff0000, v71
    v_lshlrev_b32 v136, 16, v75
    s_mov_b32 exec_hi, s101
    buffer_load_dwordx4 v10, s[12:15], s73 offen offset:1792 lds
    buffer_load_dwordx4 v11, s[12:15], s73 offen offset:2688 lds
    s_mov_b32 exec_hi, -1
    v_and_b32 v137, 0xffff0000, v75
    v_lshlrev_b32 v138, 16, v79
    v_and_b32 v139, 0xffff0000, v79
    v_lshlrev_b32 v140, 16, v83
    v_and_b32 v141, 0xffff0000, v83
    v_lshlrev_b32 v142, 16, v87
    v_and_b32 v143, 0xffff0000, v87
    v_lshlrev_b32 v144, 16, v91
    v_and_b32 v145, 0xffff0000, v91
    v_lshlrev_b32 v146, 16, v95
    s_add_u32 m0, s71, 3584
    s_mov_b32 exec_hi, s101
    buffer_load_dwordx4 v12, s[12:15], s73 offen offset:0 lds
    buffer_load_dwordx4 v13, s[12:15], s73 offen offset:896 lds
    s_mov_b32 exec_hi, -1
    v_and_b32 v147, 0xffff0000, v95
    v_lshlrev_b32 v148, 16, v99
    v_and_b32 v149, 0xffff0000, v99
    v_lshlrev_b32 v150, 16, v103
    v_and_b32 v151, 0xffff0000, v103
    v_lshlrev_b32 v152, 16, v107
    v_and_b32 v153, 0xffff0000, v107
    v_mul_f32 v176, v116, v114
    v_mul_f32 v177, v117, v115
    v_fmac_f32 v176, v118, v112
    s_mov_b32 exec_hi, s101
    buffer_load_dwordx4 v14, s[12:15], s73 offen offset:1792 lds
    buffer_load_dwordx4 v15, s[12:15], s73 offen offset:2688 lds
    s_mov_b32 exec_hi, -1
    v_fmac_f32 v177, v119, v113
    v_fmac_f32 v176, v120, v110
    v_fmac_f32 v177, v121, v111
    v_fmac_f32 v176, v122, v108
    v_fmac_f32 v177, v123, v109
    v_mul_f32 v138, v176, v138
    v_mul_f32 v139, v177, v139
    v_mul_f32 v178, v118, v114
    v_mul_f32 v179, v119, v115
    v_fmac_f32 v178, v120, v112
    s_waitcnt vmcnt(14)
    s_barrier
    s_bfe_u32 s63, s87, 0x40008
    s_add_u32 m0, s70, 70656
    s_lshl_b32 s72, s63, 7
    buffer_load_dwordx4 v4, s[8:11], s72 offen offset:0 lds
    s_mul_i32 s73, s63, 458752
    s_load_dwordx2 s[82:83], s[80:81], 4156
    s_load_dwordx2 s[82:83], s[80:81], 4284
    s_load_dwordx2 s[82:83], s[80:81], 4412
    s_load_dwordx2 s[82:83], s[80:81], 4540
    v_fmac_f32 v179, v121, v113
    v_fmac_f32 v178, v122, v110
    v_fmac_f32 v179, v123, v111
    v_fmac_f32 v178, v124, v108
    v_fmac_f32 v179, v125, v109
    v_mul_f32 v140, v178, v140
    v_mul_f32 v141, v179, v141
    buffer_load_dwordx4 v5, s[8:11], s72 offen offset:1024 lds
    v_mul_f32 v176, v120, v114
    v_mul_f32 v177, v121, v115
    v_fmac_f32 v176, v122, v112
    v_fmac_f32 v177, v123, v113
    v_fmac_f32 v176, v124, v110
    v_fmac_f32 v177, v125, v111
    v_fmac_f32 v176, v126, v108
    v_fmac_f32 v177, v127, v109
    v_mul_f32 v142, v176, v142
    v_mul_f32 v143, v177, v143
    buffer_load_dwordx4 v6, s[8:11], s72 offen offset:2048 lds
    v_mul_f32 v178, v122, v114
    v_mul_f32 v179, v123, v115
    v_fmac_f32 v178, v124, v112
    v_fmac_f32 v179, v125, v113
    v_fmac_f32 v178, v126, v110
    v_fmac_f32 v179, v127, v111
    v_fmac_f32 v178, v128, v108
    v_fmac_f32 v179, v129, v109
    v_mul_f32 v144, v178, v144
    v_mul_f32 v145, v179, v145
    buffer_load_dwordx4 v7, s[8:11], s72 offen offset:3072 lds
    v_mul_f32 v176, v124, v114
    v_mul_f32 v177, v125, v115
    v_fmac_f32 v176, v126, v112
    v_fmac_f32 v177, v127, v113
    v_fmac_f32 v176, v128, v110
    v_fmac_f32 v177, v129, v111
    v_fmac_f32 v176, v130, v108
    v_fmac_f32 v177, v131, v109
    v_mul_f32 v146, v176, v146
    v_mul_f32 v147, v177, v147
    s_add_u32 m0, s71, 70656
    s_mov_b32 exec_hi, s101
    buffer_load_dwordx4 v8, s[12:15], s73 offen offset:0 lds
    buffer_load_dwordx4 v9, s[12:15], s73 offen offset:896 lds
    s_mov_b32 exec_hi, -1
    v_mul_f32 v178, v126, v114
    v_mul_f32 v179, v127, v115
    v_fmac_f32 v178, v128, v112
    v_fmac_f32 v179, v129, v113
    v_fmac_f32 v178, v130, v110
    v_fmac_f32 v179, v131, v111
    v_fmac_f32 v178, v132, v108
    v_fmac_f32 v179, v133, v109
    v_mul_f32 v148, v178, v148
    v_mul_f32 v149, v179, v149
    s_mov_b32 exec_hi, s101
    buffer_load_dwordx4 v10, s[12:15], s73 offen offset:1792 lds
    buffer_load_dwordx4 v11, s[12:15], s73 offen offset:2688 lds
    s_mov_b32 exec_hi, -1
    v_mul_f32 v176, v128, v114
    v_mul_f32 v177, v129, v115
    v_fmac_f32 v176, v130, v112
    v_fmac_f32 v177, v131, v113
    v_fmac_f32 v176, v132, v110
    v_fmac_f32 v177, v133, v111
    v_fmac_f32 v176, v134, v108
    v_fmac_f32 v177, v135, v109
    v_mul_f32 v150, v176, v150
    v_mul_f32 v151, v177, v151
    s_add_u32 m0, s71, 74240
    s_mov_b32 exec_hi, s101
    buffer_load_dwordx4 v12, s[12:15], s73 offen offset:0 lds
    buffer_load_dwordx4 v13, s[12:15], s73 offen offset:896 lds
    s_mov_b32 exec_hi, -1
    v_mul_f32 v178, v130, v114
    v_mul_f32 v179, v131, v115
    v_fmac_f32 v178, v132, v112
    v_fmac_f32 v179, v133, v113
    v_fmac_f32 v178, v134, v110
    v_fmac_f32 v179, v135, v111
    v_fmac_f32 v178, v136, v108
    v_fmac_f32 v179, v137, v109
    v_mul_f32 v152, v178, v152
    v_mul_f32 v153, v179, v153
    s_mov_b32 exec_hi, s101
    buffer_load_dwordx4 v14, s[12:15], s73 offen offset:1792 lds
    buffer_load_dwordx4 v15, s[12:15], s73 offen offset:2688 lds
    s_mov_b32 exec_hi, -1
    v_cvt_pk_bf16_f32 v162, v152, v150
    v_cvt_pk_bf16_f32 v163, v148, v146
    v_cvt_pk_bf16_f32 v164, v144, v142
    v_cvt_pk_bf16_f32 v165, v140, v138
    v_cvt_pk_bf16_f32 v166, v153, v151
    v_cvt_pk_bf16_f32 v167, v149, v147
    v_cvt_pk_bf16_f32 v168, v145, v143
    v_cvt_pk_bf16_f32 v169, v141, v139
    s_mov_b32 s60, 98304
    buffer_store_dwordx4 v[162:165], v175, s[20:23], s60 offen sc1
    s_mov_b32 s60, 114688
    buffer_store_dwordx4 v[166:169], v175, s[20:23], s60 offen sc1
    s_mov_b32 s24, s44
    s_mov_b32 s25, s45
    s_mov_b32 s26, 0x400000
    s_mov_b32 s27, 0x20000
    v_lshlrev_b32 v2, 4, v1
    buffer_load_dwordx4 v[232:235], v2, s[24:27], s69 offen offset:0 nt
    buffer_load_dwordx4 v[236:239], v2, s[24:27], s69 offen offset:1024 nt
    buffer_load_dwordx4 v[240:243], v2, s[24:27], s69 offen offset:2048 nt
    buffer_load_dwordx4 v[244:247], v2, s[24:27], s69 offen offset:3072 nt
    s_waitcnt vmcnt(18)
    s_barrier
    s_bfe_u32 s63, s87, 0x4000c
    s_add_u32 m0, s70, 115712
    s_lshl_b32 s72, s63, 7
    buffer_load_dwordx4 v4, s[8:11], s72 offen offset:0 lds
    s_mul_i32 s73, s63, 458752
    s_load_dwordx2 s[82:83], s[80:81], 4668
    buffer_load_dwordx4 v5, s[8:11], s72 offen offset:1024 lds
    buffer_load_dwordx4 v6, s[8:11], s72 offen offset:2048 lds
    s_load_dwordx2 s[82:83], s[80:81], 4796
    buffer_load_dwordx4 v7, s[8:11], s72 offen offset:3072 lds
    s_add_u32 m0, s71, 115712
    s_mov_b32 exec_hi, s101
    buffer_load_dwordx4 v8, s[12:15], s73 offen offset:0 lds
    buffer_load_dwordx4 v9, s[12:15], s73 offen offset:896 lds
    s_mov_b32 exec_hi, -1
    s_load_dwordx2 s[82:83], s[80:81], 4924
    s_mov_b32 exec_hi, s101
    buffer_load_dwordx4 v10, s[12:15], s73 offen offset:1792 lds
    buffer_load_dwordx4 v11, s[12:15], s73 offen offset:2688 lds
    s_mov_b32 exec_hi, -1
    s_add_u32 m0, s71, 119296
    s_mov_b32 exec_hi, s101
    buffer_load_dwordx4 v12, s[12:15], s73 offen offset:0 lds
    buffer_load_dwordx4 v13, s[12:15], s73 offen offset:896 lds
    s_mov_b32 exec_hi, -1
    s_load_dwordx2 s[82:83], s[80:81], 5052
    s_mov_b32 exec_hi, s101
    buffer_load_dwordx4 v14, s[12:15], s73 offen offset:1792 lds
    buffer_load_dwordx4 v15, s[12:15], s73 offen offset:2688 lds
    s_mov_b32 exec_hi, -1
    s_waitcnt vmcnt(18)
    s_barrier
    s_bfe_u32 s63, s87, 0x40010
    s_add_u32 m0, s70, 0
    s_lshl_b32 s72, s63, 7
    buffer_load_dwordx4 v4, s[8:11], s72 offen offset:0 lds
    s_mul_i32 s73, s63, 458752
    s_load_dwordx2 s[82:83], s[80:81], 5180
    s_load_dwordx2 s[82:83], s[80:81], 5308
    s_load_dwordx2 s[82:83], s[80:81], 5436
    s_load_dwordx2 s[82:83], s[80:81], 5564
    s_waitcnt vmcnt(17)
    buffer_load_dwordx4 v5, s[8:11], s72 offen offset:1024 lds
    s_lshl_b32 s61, s74, 8
    s_lshl_b32 s60, s75, 4
    s_add_u32 s61, s61, s60
    s_lshl_b32 s60, s32, 3
    s_add_u32 s61, s61, s60
    s_add_u32 s61, s61, 8192
    v_mov_b32 v248, s94
    v_mov_b32 v249, s95
    s_mov_b64 exec, 1
    buffer_store_dwordx2 v[248:249], off, s[28:31], s61 sc1
    s_mov_b64 exec, -1
    s_mul_i32 s60, s33, 20224
    s_add_u32 s60, s60, 79872
    v_lshlrev_b32 v196, 4, v1
    v_add_u32 v197, s60, v196
    v_lshrrev_b32 v2, 4, v1
    v_lshl_add_u32 v198, v2, 5, v197
    v_and_b32 v3, 15, v1
    v_add_u32 v199, v3, v2
    v_lshl_add_u32 v199, v199, 4, s60
    v_bfe_u32 v206, v1, 2, 2
    v_sub_u32 v211, 3, v206
    v_mul_u32_u24 v211, 288, v211
    v_add_u32 v211, s60, v211
    s_lshl_b32 s61, s32, 15
    s_add_u32 s62, s6, s61
    v_lshlrev_b32 v204, 1, v2
    v_xor_b32 v204, v204, v1
    v_and_b32 v204, 7, v204
    v_lshl_add_u32 v204, v204, 4, s62
    v_lshrrev_b32 v3, 3, v3
    v_mul_u32_u24 v3, s7, v3
    v_xor_b32 v3, v3, v204
    v_lshl_add_u32 v200, v2, 11, v3
    v_xor_b32 v3, s7, v200
    buffer_load_dwordx4 v6, s[8:11], s72 offen offset:2048 lds
    v_add_u32 v201, 7168, v3
    v_add_u32 v202, 14336, v200
    v_add_u32 v203, 21504, v3
    v_lshrrev_b32 v3, 3, v1
    buffer_load_dwordx4 v7, s[8:11], s72 offen offset:3072 lds
    v_lshl_add_u32 v204, v3, 11, v204
    v_add_u32 v205, 15360, v204
    v_and_b32 v3, 3, v1
    v_lshlrev_b32 v207, 6, v2
    s_add_u32 m0, s71, 0
    s_mov_b32 exec_hi, s101
    buffer_load_dwordx4 v8, s[12:15], s73 offen offset:0 lds
    buffer_load_dwordx4 v9, s[12:15], s73 offen offset:896 lds
    s_mov_b32 exec_hi, -1
    v_lshl_add_u32 v206, v206, 8, v207
    v_lshl_add_u32 v206, v3, 4, v206
    v_lshl_add_u32 v211, v2, 4, v211
    v_and_b32 v2, 1, v1
    s_mov_b32 exec_hi, s101
    buffer_load_dwordx4 v10, s[12:15], s73 offen offset:1792 lds
    buffer_load_dwordx4 v11, s[12:15], s73 offen offset:2688 lds
    s_mov_b32 exec_hi, -1
    v_sub_u32 v2, 1, v2
    v_mul_u32_u24 v2, 5760, v2
    v_bfe_u32 v3, v1, 1, 1
    v_sub_u32 v3, 1, v3
    s_add_u32 m0, s71, 3584
    s_mov_b32 exec_hi, s101
    buffer_load_dwordx4 v12, s[12:15], s73 offen offset:0 lds
    buffer_load_dwordx4 v13, s[12:15], s73 offen offset:896 lds
    s_mov_b32 exec_hi, -1
    v_lshlrev_b32 v3, 3, v3
    v_add3_u32 v211, v211, v2, v3
    v_and_b32 v2, 50, v1
    v_add_u32 v3, 32, v211
    s_mov_b32 exec_hi, s101
    buffer_load_dwordx4 v14, s[12:15], s73 offen offset:1792 lds
    buffer_load_dwordx4 v15, s[12:15], s73 offen offset:2688 lds
    s_mov_b32 exec_hi, -1
    v_cmp_eq_u32 vcc, 48, v2
    s_nop 1
    v_cndmask_b32 v207, v211, v3, vcc
    v_and_b32 v212, 3, v1
    v_lshlrev_b32 v212, 2, v212
    v_add_u32 v212, 161664, v212
    s_waitcnt vmcnt(13)
    s_barrier
    s_bfe_u32 s63, s87, 0x40014
    s_add_u32 m0, s70, 70656
    s_lshl_b32 s72, s63, 7
    buffer_load_dwordx4 v4, s[8:11], s72 offen offset:0 lds
    s_mul_i32 s73, s63, 458752
    s_load_dwordx2 s[82:83], s[80:81], 5692
    buffer_load_dwordx4 v5, s[8:11], s72 offen offset:1024 lds
    buffer_load_dwordx4 v6, s[8:11], s72 offen offset:2048 lds
    s_load_dwordx2 s[82:83], s[80:81], 5820
    buffer_load_dwordx4 v7, s[8:11], s72 offen offset:3072 lds
    s_add_u32 m0, s71, 70656
    s_mov_b32 exec_hi, s101
    buffer_load_dwordx4 v8, s[12:15], s73 offen offset:0 lds
    buffer_load_dwordx4 v9, s[12:15], s73 offen offset:896 lds
    s_mov_b32 exec_hi, -1
    s_load_dwordx2 s[82:83], s[80:81], 5948
    s_mov_b32 exec_hi, s101
    buffer_load_dwordx4 v10, s[12:15], s73 offen offset:1792 lds
    buffer_load_dwordx4 v11, s[12:15], s73 offen offset:2688 lds
    s_mov_b32 exec_hi, -1
    s_add_u32 m0, s71, 74240
    s_mov_b32 exec_hi, s101
    buffer_load_dwordx4 v12, s[12:15], s73 offen offset:0 lds
    buffer_load_dwordx4 v13, s[12:15], s73 offen offset:896 lds
    s_mov_b32 exec_hi, -1
    s_load_dwordx2 s[82:83], s[80:81], 6076
    s_mov_b32 exec_hi, s101
    buffer_load_dwordx4 v14, s[12:15], s73 offen offset:1792 lds
    buffer_load_dwordx4 v15, s[12:15], s73 offen offset:2688 lds
    s_mov_b32 exec_hi, -1
    s_waitcnt vmcnt(12)
    s_barrier
    s_bfe_u32 s63, s87, 0x40018
    s_add_u32 m0, s70, 115712
    s_lshl_b32 s72, s63, 7
    buffer_load_dwordx4 v4, s[8:11], s72 offen offset:0 lds
    s_mul_i32 s73, s63, 458752
    s_load_dwordx2 s[82:83], s[80:81], 6204
    s_load_dwordx2 s[82:83], s[80:81], 6332
    s_load_dwordx2 s[82:83], s[80:81], 6460
    s_load_dwordx2 s[82:83], s[80:81], 6588
    v_mov_b32 v160, 0
    buffer_load_dwordx4 v5, s[8:11], s72 offen offset:1024 lds
    v_mov_b32 v161, 0
    v_mov_b32 v162, 0
    v_mov_b32 v163, 0
    v_mov_b32 v164, 0
    buffer_load_dwordx4 v6, s[8:11], s72 offen offset:2048 lds
    v_mov_b32 v165, 0
    v_mov_b32 v166, 0
    v_mov_b32 v167, 0
    v_mov_b32 v168, 0
    v_mov_b32 v169, 0
    buffer_load_dwordx4 v7, s[8:11], s72 offen offset:3072 lds
    v_mov_b32 v170, 0
    v_mov_b32 v171, 0
    v_mov_b32 v172, 0
    v_mov_b32 v173, 0
    s_add_u32 m0, s71, 115712
    s_mov_b32 exec_hi, s101
    buffer_load_dwordx4 v8, s[12:15], s73 offen offset:0 lds
    buffer_load_dwordx4 v9, s[12:15], s73 offen offset:896 lds
    s_mov_b32 exec_hi, -1
    v_mov_b32 v174, 0
    v_mov_b32 v175, 0
    v_mov_b32 v176, 0
    v_mov_b32 v177, 0
    v_mov_b32 v178, 0
    s_mov_b32 exec_hi, s101
    buffer_load_dwordx4 v10, s[12:15], s73 offen offset:1792 lds
    buffer_load_dwordx4 v11, s[12:15], s73 offen offset:2688 lds
    s_mov_b32 exec_hi, -1
    v_mov_b32 v179, 0
    v_mov_b32 v180, 0
    v_mov_b32 v181, 0
    v_mov_b32 v182, 0
    s_add_u32 m0, s71, 119296
    s_mov_b32 exec_hi, s101
    buffer_load_dwordx4 v12, s[12:15], s73 offen offset:0 lds
    buffer_load_dwordx4 v13, s[12:15], s73 offen offset:896 lds
    s_mov_b32 exec_hi, -1
    v_mov_b32 v183, 0
    v_mov_b32 v184, 0
    v_mov_b32 v185, 0
    v_mov_b32 v186, 0
    v_mov_b32 v187, 0
    s_mov_b32 exec_hi, s101
    buffer_load_dwordx4 v14, s[12:15], s73 offen offset:1792 lds
    buffer_load_dwordx4 v15, s[12:15], s73 offen offset:2688 lds
    s_mov_b32 exec_hi, -1
    v_mov_b32 v188, 0
    v_mov_b32 v189, 0
    v_mov_b32 v190, 0
    v_mov_b32 v191, 0
    s_waitcnt vmcnt(12)
    s_barrier
    s_bfe_u32 s63, s87, 0x4001c
    s_add_u32 m0, s70, 0
    s_lshl_b32 s72, s63, 7
    buffer_load_dwordx4 v4, s[8:11], s72 offen offset:0 lds
    s_mul_i32 s73, s63, 458752
    s_load_dwordx2 s[82:83], s[80:81], 6716
    s_load_dwordx2 s[82:83], s[80:81], 6844
    s_load_dwordx2 s[82:83], s[80:81], 6972
    buffer_load_dwordx4 v5, s[8:11], s72 offen offset:1024 lds
    s_load_dwordx2 s[82:83], s[80:81], 7100
    s_lshr_b32 s60, s67, 16
    s_and_b32 s61, s68, 1
    s_cmp_eq_u32 s61, 1
    s_cselect_b32 s60, s60, s67
    s_lshl_b32 s60, s60, 16
    s_mov_b64 exec, 1
    v_lshlrev_b32 v2, 16, v232
    v_and_b32 v3, 0xffff0000, v232
    v_add_f32 v2, s60, v2
    v_cvt_pk_bf16_f32 v232, v2, v3
    s_mov_b64 exec, -1
    buffer_load_dwordx4 v6, s[8:11], s72 offen offset:2048 lds
    v_mov_b32_dpp v2, v235 wave_shr:1 row_mask:0xf bank_mask:0xf bound_ctrl:0
    v_alignbit_b32 v128, v232, v2, 16
    v_alignbit_b32 v129, v233, v232, 16
    v_alignbit_b32 v130, v234, v233, 16
    buffer_load_dwordx4 v7, s[8:11], s72 offen offset:3072 lds
    v_alignbit_b32 v131, v235, v234, 16
    v_mov_b32_dpp v2, v239 wave_shr:1 row_mask:0xf bank_mask:0xf bound_ctrl:0
    v_readlane_b32 s61, v235, 63
    s_nop 3
    v_writelane_b32 v2, s61, 0
    v_alignbit_b32 v132, v236, v2, 16
    v_alignbit_b32 v133, v237, v236, 16
    s_add_u32 m0, s71, 0
    s_mov_b32 exec_hi, s101
    buffer_load_dwordx4 v8, s[12:15], s73 offen offset:0 lds
    buffer_load_dwordx4 v9, s[12:15], s73 offen offset:896 lds
    s_mov_b32 exec_hi, -1
    v_alignbit_b32 v134, v238, v237, 16
    v_alignbit_b32 v135, v239, v238, 16
    v_mov_b32_dpp v2, v243 wave_shr:1 row_mask:0xf bank_mask:0xf bound_ctrl:0
    v_readlane_b32 s61, v239, 63
    s_nop 3
    v_writelane_b32 v2, s61, 0
    v_alignbit_b32 v136, v240, v2, 16
    s_mov_b32 exec_hi, s101
    buffer_load_dwordx4 v10, s[12:15], s73 offen offset:1792 lds
    buffer_load_dwordx4 v11, s[12:15], s73 offen offset:2688 lds
    s_mov_b32 exec_hi, -1
    v_alignbit_b32 v137, v241, v240, 16
    v_alignbit_b32 v138, v242, v241, 16
    v_alignbit_b32 v139, v243, v242, 16
    s_add_u32 m0, s71, 3584
    s_mov_b32 exec_hi, s101
    buffer_load_dwordx4 v12, s[12:15], s73 offen offset:0 lds
    buffer_load_dwordx4 v13, s[12:15], s73 offen offset:896 lds
    s_mov_b32 exec_hi, -1
    v_mov_b32_dpp v2, v247 wave_shr:1 row_mask:0xf bank_mask:0xf bound_ctrl:0
    v_readlane_b32 s61, v243, 63
    s_nop 3
    v_writelane_b32 v2, s61, 0
    v_alignbit_b32 v140, v244, v2, 16
    v_alignbit_b32 v141, v245, v244, 16
    v_alignbit_b32 v142, v246, v245, 16
    s_mov_b32 exec_hi, s101
    buffer_load_dwordx4 v14, s[12:15], s73 offen offset:1792 lds
    buffer_load_dwordx4 v15, s[12:15], s73 offen offset:2688 lds
    s_mov_b32 exec_hi, -1
    v_alignbit_b32 v143, v247, v246, 16
    s_lshr_b32 s74, s2, 4
    s_lshl_b32 s74, s74, 8
    s_add_u32 s74, s74, 8192
    v_min_u32 v210, 31, v1
    v_lshlrev_b32 v210, 3, v210
    v_and_b32 v213, 255, v196
    buffer_load_dwordx4 v[192:195], v213, s[28:31], s74 offen sc1
    s_waitcnt vmcnt(13)
    s_barrier
    s_lshl_b32 s60, s4, 18
    s_lshl_b32 s61, s32, 17
    s_add_u32 s60, s60, s61
    s_add_u32 s60, s60, s6
    s_lshr_b32 s61, s33, 1
    s_lshl_b32 s61, s61, 6
    s_add_u32 s60, s60, s61
    v_lshrrev_b32 v2, 2, v1
    v_and_b32 v3, 3, v1
    v_lshlrev_b32 v3, 4, v3
    v_lshl_add_u32 v2, v2, 11, v3
    s_add_u32 m0, s70, 49152
    s_add_u32 s61, s60, 0
    buffer_load_dwordx4 v2, s[8:11], s61 offen offset:0 lds
    s_add_u32 s61, s60, 31744
    buffer_load_dwordx4 v2, s[8:11], s61 offen offset:1024 lds
    s_add_u32 s61, s60, 63488
    buffer_load_dwordx4 v2, s[8:11], s61 offen offset:2048 lds
    s_add_u32 s61, s60, 95232
    buffer_load_dwordx4 v2, s[8:11], s61 offen offset:3072 lds
    s_waitcnt vmcnt(5)
    s_barrier
    s_waitcnt vmcnt(4)
    v_cmp_ne_u64 vcc, s[94:95], v[192:193]
    v_cmp_ne_u64 s[60:61], s[94:95], v[194:195]
    s_or_b64 vcc, vcc, s[60:61]
    s_cselect_b32 s35, 1, 0
    s_add_u32 s24, s58, 0x1000000
    s_addc_u32 s25, s59, 0
    s_mov_b32 s26, 0x400000
    s_mov_b32 s27, 0x20000
    s_lshl_b32 s64, s2, 14
    s_lshl_b32 s61, s33, 4
    s_add_u32 s64, s64, s61
    v_lshlrev_b32 v2, 6, v1
    buffer_load_dwordx4 v[216:219], v2, s[24:27], s64 offen sc1
    s_add_u32 s64, s64, 4096
    buffer_load_dwordx4 v[220:223], v2, s[24:27], s64 offen sc1
    s_add_u32 s64, s64, 4096
    buffer_load_dwordx4 v[224:227], v2, s[24:27], s64 offen sc1
    s_add_u32 s64, s64, 4096
    buffer_load_dwordx4 v[228:231], v2, s[24:27], s64 offen sc1
    s_add_u32 s64, s64, 4096
    s_waitcnt vmcnt(4)
    s_branch L_conv_start
L_progA:
    s_bfe_u32 s63, s86, 0x40004
    s_add_u32 m0, s70, 70656
    s_lshl_b32 s72, s63, 7
    buffer_load_dwordx4 v4, s[8:11], s72 offen offset:0 lds
    s_mul_i32 s73, s63, 458752
    s_add_u32 s16, s58, 0x1800000
    s_addc_u32 s17, s59, 0
    s_mov_b32 s18, 0x8000
    s_mov_b32 s19, 0x20000
    buffer_load_dwordx4 v5, s[8:11], s72 offen offset:1024 lds
    buffer_load_dwordx4 v6, s[8:11], s72 offen offset:2048 lds
    buffer_load_dwordx4 v7, s[8:11], s72 offen offset:3072 lds
    s_add_u32 m0, s71, 70656
    s_mov_b32 exec_hi, s101
    buffer_load_dwordx4 v8, s[12:15], s73 offen offset:0 lds
    buffer_load_dwordx4 v9, s[12:15], s73 offen offset:896 lds
    s_mov_b32 exec_hi, -1
    s_add_u32 s20, s58, 0x1810000
    s_addc_u32 s21, s59, 0
    s_mov_b32 s22, 0x38000
    s_mov_b32 s23, 0x20000
    s_mov_b32 exec_hi, s101
    buffer_load_dwordx4 v10, s[12:15], s73 offen offset:1792 lds
    buffer_load_dwordx4 v11, s[12:15], s73 offen offset:2688 lds
    s_mov_b32 exec_hi, -1
    s_add_u32 m0, s71, 74240
    s_mov_b32 exec_hi, s101
    buffer_load_dwordx4 v12, s[12:15], s73 offen offset:0 lds
    buffer_load_dwordx4 v13, s[12:15], s73 offen offset:896 lds
    s_mov_b32 exec_hi, -1
    s_mov_b32 exec_hi, s101
    buffer_load_dwordx4 v14, s[12:15], s73 offen offset:1792 lds
    buffer_load_dwordx4 v15, s[12:15], s73 offen offset:2688 lds
    s_mov_b32 exec_hi, -1
    s_waitcnt lgkmcnt(0)
    s_mul_i32 s94, s96, 0x4c957f2d
    s_mul_hi_u32 s95, s96, 0x4c957f2d
    s_mul_i32 s60, s96, 0x5851f42d
    s_add_u32 s95, s95, s60
    s_mul_i32 s60, s97, 0x4c957f2d
    s_add_u32 s95, s95, s60
    s_add_u32 s94, s94, 0xf767814f
    s_addc_u32 s95, s95, 0x14057b7e
    s_waitcnt vmcnt(12)
    s_barrier
    s_bfe_u32 s63, s86, 0x40008
    s_add_u32 m0, s70, 115712
    s_lshl_b32 s72, s63, 7
    buffer_load_dwordx4 v4, s[8:11], s72 offen offset:0 lds
    s_mul_i32 s73, s63, 458752
    s_load_dwordx2 s[82:83], s[80:81], 60
    buffer_load_dwordx4 v5, s[8:11], s72 offen offset:1024 lds
    buffer_load_dwordx4 v6, s[8:11], s72 offen offset:2048 lds
    s_load_dwordx2 s[82:83], s[80:81], 188
    buffer_load_dwordx4 v7, s[8:11], s72 offen offset:3072 lds
    s_add_u32 m0, s71, 115712
    s_mov_b32 exec_hi, s101
    buffer_load_dwordx4 v8, s[12:15], s73 offen offset:0 lds
    buffer_load_dwordx4 v9, s[12:15], s73 offen offset:896 lds
    s_mov_b32 exec_hi, -1
    s_load_dwordx2 s[82:83], s[80:81], 316
    s_mov_b32 exec_hi, s101
    buffer_load_dwordx4 v10, s[12:15], s73 offen offset:1792 lds
    buffer_load_dwordx4 v11, s[12:15], s73 offen offset:2688 lds
    s_mov_b32 exec_hi, -1
    s_add_u32 m0, s71, 119296
    s_mov_b32 exec_hi, s101
    buffer_load_dwordx4 v12, s[12:15], s73 offen offset:0 lds
    buffer_load_dwordx4 v13, s[12:15], s73 offen offset:896 lds
    s_mov_b32 exec_hi, -1
    s_load_dwordx2 s[82:83], s[80:81], 444
    s_mov_b32 exec_hi, s101
    buffer_load_dwordx4 v14, s[12:15], s73 offen offset:1792 lds
    buffer_load_dwordx4 v15, s[12:15], s73 offen offset:2688 lds
    s_mov_b32 exec_hi, -1
    s_waitcnt vmcnt(12)
    s_barrier
    s_bfe_u32 s63, s86, 0x4000c
    s_add_u32 m0, s70, 0
    s_lshl_b32 s72, s63, 7
    buffer_load_dwordx4 v4, s[8:11], s72 offen offset:0 lds
    s_mul_i32 s73, s63, 458752
    s_load_dwordx2 s[82:83], s[80:81], 572
    s_load_dwordx2 s[82:83], s[80:81], 700
    buffer_load_dwordx4 v5, s[8:11], s72 offen offset:1024 lds
    s_load_dwordx2 s[82:83], s[80:81], 828
    buffer_load_dwordx4 v6, s[8:11], s72 offen offset:2048 lds
    s_load_dwordx2 s[82:83], s[80:81], 956
    s_lshl_b32 s60, s2, 3
    buffer_load_dwordx4 v7, s[8:11], s72 offen offset:3072 lds
    s_lshl_b32 s61, s32, 2
    s_add_u32 m0, s71, 0
    s_mov_b32 exec_hi, s101
    buffer_load_dwordx4 v8, s[12:15], s73 offen offset:0 lds
    buffer_load_dwordx4 v9, s[12:15], s73 offen offset:896 lds
    s_mov_b32 exec_hi, -1
    s_add_u32 s60, s60, s61
    v_lshrrev_b32 v2, 4, v1
    s_mov_b32 exec_hi, s101
    buffer_load_dwordx4 v10, s[12:15], s73 offen offset:1792 lds
    buffer_load_dwordx4 v11, s[12:15], s73 offen offset:2688 lds
    s_mov_b32 exec_hi, -1
    v_add_u32 v2, s60, v2
    s_add_u32 m0, s71, 3584
    s_mov_b32 exec_hi, s101
    buffer_load_dwordx4 v12, s[12:15], s73 offen offset:0 lds
    buffer_load_dwordx4 v13, s[12:15], s73 offen offset:896 lds
    s_mov_b32 exec_hi, -1
    v_and_b32 v3, 15, v1
    v_lshlrev_b32 v3, 4, v3
    s_mov_b32 exec_hi, s101
    buffer_load_dwordx4 v14, s[12:15], s73 offen offset:1792 lds
    buffer_load_dwordx4 v15, s[12:15], s73 offen offset:2688 lds
    s_mov_b32 exec_hi, -1
    v_lshl_add_u32 v120, v2, 11, v3
    buffer_load_dwordx4 v[16:19], v120, s[8:11], 0 offen offset:0
    buffer_load_dwordx4 v[20:23], v120, s[8:11], 0 offen offset:256
    buffer_load_dwordx4 v[24:27], v120, s[8:11], 0 offen offset:512
    buffer_load_dwordx4 v[28:31], v120, s[8:11], 0 offen offset:768
    buffer_load_dwordx4 v[32:35], v120, s[8:11], 0 offen offset:1024
    buffer_load_dwordx4 v[36:39], v120, s[8:11], 0 offen offset:1280
    buffer_load_dwordx4 v[40:43], v120, s[8:11], 0 offen offset:1536
    buffer_load_dwordx4 v[44:47], v120, s[8:11], 0 offen offset:1792
    s_waitcnt vmcnt(20)
    s_barrier
    s_bfe_u32 s63, s86, 0x40010
    s_add_u32 m0, s70, 70656
    s_lshl_b32 s72, s63, 7
    buffer_load_dwordx4 v4, s[8:11], s72 offen offset:0 lds
    s_mul_i32 s73, s63, 458752
    s_load_dwordx2 s[82:83], s[80:81], 1084
    buffer_load_dwordx4 v5, s[8:11], s72 offen offset:1024 lds
    buffer_load_dwordx4 v6, s[8:11], s72 offen offset:2048 lds
    s_load_dwordx2 s[82:83], s[80:81], 1212
    buffer_load_dwordx4 v7, s[8:11], s72 offen offset:3072 lds
    s_add_u32 m0, s71, 70656
    s_mov_b32 exec_hi, s101
    buffer_load_dwordx4 v8, s[12:15], s73 offen offset:0 lds
    buffer_load_dwordx4 v9, s[12:15], s73 offen offset:896 lds
    s_mov_b32 exec_hi, -1
    s_load_dwordx2 s[82:83], s[80:81], 1340
    s_mov_b32 exec_hi, s101
    buffer_load_dwordx4 v10, s[12:15], s73 offen offset:1792 lds
    buffer_load_dwordx4 v11, s[12:15], s73 offen offset:2688 lds
    s_mov_b32 exec_hi, -1
    s_add_u32 m0, s71, 74240
    s_mov_b32 exec_hi, s101
    buffer_load_dwordx4 v12, s[12:15], s73 offen offset:0 lds
    buffer_load_dwordx4 v13, s[12:15], s73 offen offset:896 lds
    s_mov_b32 exec_hi, -1
    s_load_dwordx2 s[82:83], s[80:81], 1468
    s_mov_b32 exec_hi, s101
    buffer_load_dwordx4 v14, s[12:15], s73 offen offset:1792 lds
    buffer_load_dwordx4 v15, s[12:15], s73 offen offset:2688 lds
    s_mov_b32 exec_hi, -1
    s_waitcnt vmcnt(20)
    s_barrier
    s_bfe_u32 s63, s86, 0x40014
    s_add_u32 m0, s70, 115712
    s_lshl_b32 s72, s63, 7
    buffer_load_dwordx4 v4, s[8:11], s72 offen offset:0 lds
    s_mul_i32 s73, s63, 458752
    s_load_dwordx2 s[82:83], s[80:81], 1596
    s_load_dwordx2 s[82:83], s[80:81], 1724
    s_load_dwordx2 s[82:83], s[80:81], 1852
    s_load_dwordx2 s[82:83], s[80:81], 1980
    s_waitcnt vmcnt(13)
    v_lshlrev_b32 v48, 16, v16
    v_and_b32 v49, 0xffff0000, v16
    v_lshlrev_b32 v50, 16, v17
    buffer_load_dwordx4 v5, s[8:11], s72 offen offset:1024 lds
    v_and_b32 v51, 0xffff0000, v17
    v_lshlrev_b32 v52, 16, v18
    v_and_b32 v53, 0xffff0000, v18
    v_lshlrev_b32 v54, 16, v19
    v_and_b32 v55, 0xffff0000, v19
    v_lshlrev_b32 v56, 16, v20
    v_and_b32 v57, 0xffff0000, v20
    v_lshlrev_b32 v58, 16, v21
    buffer_load_dwordx4 v6, s[8:11], s72 offen offset:2048 lds
    v_and_b32 v59, 0xffff0000, v21
    v_lshlrev_b32 v60, 16, v22
    v_and_b32 v61, 0xffff0000, v22
    v_lshlrev_b32 v62, 16, v23
    v_and_b32 v63, 0xffff0000, v23
    v_lshlrev_b32 v64, 16, v24
    v_and_b32 v65, 0xffff0000, v24
    buffer_load_dwordx4 v7, s[8:11], s72 offen offset:3072 lds
    v_lshlrev_b32 v66, 16, v25
    v_and_b32 v67, 0xffff0000, v25
    v_lshlrev_b32 v68, 16, v26
    v_and_b32 v69, 0xffff0000, v26
    v_lshlrev_b32 v70, 16, v27
    v_and_b32 v71, 0xffff0000, v27
    v_lshlrev_b32 v72, 16, v28
    v_and_b32 v73, 0xffff0000, v28
    s_add_u32 m0, s71, 115712
    s_mov_b32 exec_hi, s101
    buffer_load_dwordx4 v8, s[12:15], s73 offen offset:0 lds
    buffer_load_dwordx4 v9, s[12:15], s73 offen offset:896 lds
    s_mov_b32 exec_hi, -1
    v_lshlrev_b32 v74, 16, v29
    v_and_b32 v75, 0xffff0000, v29
    v_lshlrev_b32 v76, 16, v30
    v_and_b32 v77, 0xffff0000, v30
    v_lshlrev_b32 v78, 16, v31
    v_and_b32 v79, 0xffff0000, v31
    v_lshlrev_b32 v80, 16, v32
    v_and_b32 v81, 0xffff0000, v32
    s_mov_b32 exec_hi, s101
    buffer_load_dwordx4 v10, s[12:15], s73 offen offset:1792 lds
    buffer_load_dwordx4 v11, s[12:15], s73 offen offset:2688 lds
    s_mov_b32 exec_hi, -1
    v_lshlrev_b32 v82, 16, v33
    v_and_b32 v83, 0xffff0000, v33
    v_lshlrev_b32 v84, 16, v34
    v_and_b32 v85, 0xffff0000, v34
    v_lshlrev_b32 v86, 16, v35
    v_and_b32 v87, 0xffff0000, v35
    v_lshlrev_b32 v88, 16, v36
    s_add_u32 m0, s71, 119296
    s_mov_b32 exec_hi, s101
    buffer_load_dwordx4 v12, s[12:15], s73 offen offset:0 lds
    buffer_load_dwordx4 v13, s[12:15], s73 offen offset:896 lds
    s_mov_b32 exec_hi, -1
    v_and_b32 v89, 0xffff0000, v36
    v_lshlrev_b32 v90, 16, v37
    v_and_b32 v91, 0xffff0000, v37
    v_lshlrev_b32 v92, 16, v38
    v_and_b32 v93, 0xffff0000, v38
    v_lshlrev_b32 v94, 16, v39
    v_and_b32 v95, 0xffff0000, v39
    v_lshlrev_b32 v96, 16, v40
    s_mov_b32 exec_hi, s101
    buffer_load_dwordx4 v14, s[12:15], s73 offen offset:1792 lds
    buffer_load_dwordx4 v15, s[12:15], s73 offen offset:2688 lds
    s_mov_b32 exec_hi, -1
    v_and_b32 v97, 0xffff0000, v40
    v_lshlrev_b32 v98, 16, v41
    v_and_b32 v99, 0xffff0000, v41
    v_lshlrev_b32 v100, 16, v42
    v_and_b32 v101, 0xffff0000, v42
    v_lshlrev_b32 v102, 16, v43
    v_and_b32 v103, 0xffff0000, v43
    s_waitcnt vmcnt(12)
    s_barrier
    s_bfe_u32 s63, s86, 0x40018
    s_add_u32 m0, s70, 0
    s_lshl_b32 s72, s63, 7
    buffer_load_dwordx4 v4, s[8:11], s72 offen offset:0 lds
    s_mul_i32 s73, s63, 458752
    s_load_dwordx2 s[82:83], s[80:81], 2108
    s_load_dwordx2 s[82:83], s[80:81], 2236
    s_load_dwordx2 s[82:83], s[80:81], 2364
    s_load_dwordx2 s[82:83], s[80:81], 2492
    v_lshlrev_b32 v104, 16, v44
    v_and_b32 v105, 0xffff0000, v44
    v_lshlrev_b32 v106, 16, v45
    v_and_b32 v107, 0xffff0000, v45
    buffer_load_dwordx4 v5, s[8:11], s72 offen offset:1024 lds
    v_lshlrev_b32 v108, 16, v46
    v_and_b32 v109, 0xffff0000, v46
    v_lshlrev_b32 v110, 16, v47
    v_and_b32 v111, 0xffff0000, v47
    v_add_f32 v112, v48, v52
    v_add_f32 v113, v49, v53
    v_add_f32 v114, v50, v54
    v_add_f32 v115, v51, v55
    buffer_load_dwordx4 v6, s[8:11], s72 offen offset:2048 lds
    v_add_f32 v112, v112, v56
    v_add_f32 v113, v113, v57
    v_add_f32 v114, v114, v58
    v_add_f32 v115, v115, v59
    v_add_f32 v112, v112, v60
    v_add_f32 v113, v113, v61
    v_add_f32 v114, v114, v62
    buffer_load_dwordx4 v7, s[8:11], s72 offen offset:3072 lds
    v_add_f32 v115, v115, v63
    v_add_f32 v112, v112, v64
    v_add_f32 v113, v113, v65
    v_add_f32 v114, v114, v66
    v_add_f32 v115, v115, v67
    v_add_f32 v112, v112, v68
    v_add_f32 v113, v113, v69
    v_add_f32 v114, v114, v70
    s_add_u32 m0, s71, 0
    s_mov_b32 exec_hi, s101
    buffer_load_dwordx4 v8, s[12:15], s73 offen offset:0 lds
    buffer_load_dwordx4 v9, s[12:15], s73 offen offset:896 lds
    s_mov_b32 exec_hi, -1
    v_add_f32 v115, v115, v71
    v_add_f32 v112, v112, v72
    v_add_f32 v113, v113, v73
    v_add_f32 v114, v114, v74
    v_add_f32 v115, v115, v75
    v_add_f32 v112, v112, v76
    v_add_f32 v113, v113, v77
    v_add_f32 v114, v114, v78
    s_mov_b32 exec_hi, s101
    buffer_load_dwordx4 v10, s[12:15], s73 offen offset:1792 lds
    buffer_load_dwordx4 v11, s[12:15], s73 offen offset:2688 lds
    s_mov_b32 exec_hi, -1
    v_add_f32 v115, v115, v79
    v_add_f32 v112, v112, v80
    v_add_f32 v113, v113, v81
    v_add_f32 v114, v114, v82
    v_add_f32 v115, v115, v83
    v_add_f32 v112, v112, v84
    v_add_f32 v113, v113, v85
    s_add_u32 m0, s71, 3584
    s_mov_b32 exec_hi, s101
    buffer_load_dwordx4 v12, s[12:15], s73 offen offset:0 lds
    buffer_load_dwordx4 v13, s[12:15], s73 offen offset:896 lds
    s_mov_b32 exec_hi, -1
    v_add_f32 v114, v114, v86
    v_add_f32 v115, v115, v87
    v_add_f32 v112, v112, v88
    v_add_f32 v113, v113, v89
    v_add_f32 v114, v114, v90
    v_add_f32 v115, v115, v91
    v_add_f32 v112, v112, v92
    v_add_f32 v113, v113, v93
    s_mov_b32 exec_hi, s101
    buffer_load_dwordx4 v14, s[12:15], s73 offen offset:1792 lds
    buffer_load_dwordx4 v15, s[12:15], s73 offen offset:2688 lds
    s_mov_b32 exec_hi, -1
    v_add_f32 v114, v114, v94
    v_add_f32 v115, v115, v95
    v_add_f32 v112, v112, v96
    v_add_f32 v113, v113, v97
    v_add_f32 v114, v114, v98
    v_add_f32 v115, v115, v99
    v_add_f32 v112, v112, v100
    s_waitcnt vmcnt(12)
    s_barrier
    s_bfe_u32 s63, s86, 0x4001c
    s_add_u32 m0, s70, 70656
    s_lshl_b32 s72, s63, 7
    buffer_load_dwordx4 v4, s[8:11], s72 offen offset:0 lds
    s_mul_i32 s73, s63, 458752
    s_load_dwordx2 s[82:83], s[80:81], 2620
    s_load_dwordx2 s[82:83], s[80:81], 2748
    s_load_dwordx2 s[82:83], s[80:81], 2876
    s_load_dwordx2 s[82:83], s[80:81], 3004
    v_add_f32 v113, v113, v101
    v_add_f32 v114, v114, v102
    v_add_f32 v115, v115, v103
    v_add_f32 v112, v112, v104
    buffer_load_dwordx4 v5, s[8:11], s72 offen offset:1024 lds
    v_add_f32 v113, v113, v105
    v_add_f32 v114, v114, v106
    v_add_f32 v115, v115, v107
    v_add_f32 v112, v112, v108
    v_add_f32 v113, v113, v109
    v_add_f32 v114, v114, v110
    v_add_f32 v115, v115, v111
    v_add_f32 v112, v112, v113
    buffer_load_dwordx4 v6, s[8:11], s72 offen offset:2048 lds
    v_add_f32 v114, v114, v115
    v_add_f32 v116, v112, v114
    s_nop 1
    v_add_f32_dpp v116, v116, v116 row_ror:8 row_mask:0xf bank_mask:0xf
    s_nop 1
    v_add_f32_dpp v116, v116, v116 row_ror:4 row_mask:0xf bank_mask:0xf
    s_nop 1
    v_add_f32_dpp v116, v116, v116 row_ror:2 row_mask:0xf bank_mask:0xf
    s_nop 1
    v_add_f32_dpp v116, v116, v116 row_ror:1 row_mask:0xf bank_mask:0xf
    v_mul_f32 v116, 0x3a800000, v116
    buffer_load_dwordx4 v7, s[8:11], s72 offen offset:3072 lds
    v_sub_f32 v48, v48, v116
    v_sub_f32 v49, v49, v116
    v_sub_f32 v50, v50, v116
    v_sub_f32 v51, v51, v116
    v_sub_f32 v52, v52, v116
    v_sub_f32 v53, v53, v116
    v_sub_f32 v54, v54, v116
    v_sub_f32 v55, v55, v116
    s_add_u32 m0, s71, 70656
    s_mov_b32 exec_hi, s101
    buffer_load_dwordx4 v8, s[12:15], s73 offen offset:0 lds
    buffer_load_dwordx4 v9, s[12:15], s73 offen offset:896 lds
    s_mov_b32 exec_hi, -1
    v_sub_f32 v56, v56, v116
    v_sub_f32 v57, v57, v116
    v_sub_f32 v58, v58, v116
    v_sub_f32 v59, v59, v116
    v_sub_f32 v60, v60, v116
    v_sub_f32 v61, v61, v116
    v_sub_f32 v62, v62, v116
    v_sub_f32 v63, v63, v116
    s_mov_b32 exec_hi, s101
    buffer_load_dwordx4 v10, s[12:15], s73 offen offset:1792 lds
    buffer_load_dwordx4 v11, s[12:15], s73 offen offset:2688 lds
    s_mov_b32 exec_hi, -1
    v_sub_f32 v64, v64, v116
    v_sub_f32 v65, v65, v116
    v_sub_f32 v66, v66, v116
    v_sub_f32 v67, v67, v116
    v_sub_f32 v68, v68, v116
    v_sub_f32 v69, v69, v116
    v_sub_f32 v70, v70, v116
    s_add_u32 m0, s71, 74240
    s_mov_b32 exec_hi, s101
    buffer_load_dwordx4 v12, s[12:15], s73 offen offset:0 lds
    buffer_load_dwordx4 v13, s[12:15], s73 offen offset:896 lds
    s_mov_b32 exec_hi, -1
    v_sub_f32 v71, v71, v116
    v_sub_f32 v72, v72, v116
    v_sub_f32 v73, v73, v116
    v_sub_f32 v74, v74, v116
    v_sub_f32 v75, v75, v116
    v_sub_f32 v76, v76, v116
    v_sub_f32 v77, v77, v116
    v_sub_f32 v78, v78, v116
    s_mov_b32 exec_hi, s101
    buffer_load_dwordx4 v14, s[12:15], s73 offen offset:1792 lds
    buffer_load_dwordx4 v15, s[12:15], s73 offen offset:2688 lds
    s_mov_b32 exec_hi, -1
    v_sub_f32 v79, v79, v116
    v_sub_f32 v80, v80, v116
    v_sub_f32 v81, v81, v116
    v_sub_f32 v82, v82, v116
    v_sub_f32 v83, v83, v116
    v_sub_f32 v84, v84, v116
    v_sub_f32 v85, v85, v116
    s_waitcnt vmcnt(12)
    s_barrier
    s_bfe_u32 s63, s87, 0x40000
    s_add_u32 m0, s70, 115712
    s_lshl_b32 s72, s63, 7
    buffer_load_dwordx4 v4, s[8:11], s72 offen offset:0 lds
    s_mul_i32 s73, s63, 458752
    s_load_dwordx2 s[82:83], s[80:81], 3132
    s_load_dwordx2 s[82:83], s[80:81], 3260
    s_load_dwordx2 s[82:83], s[80:81], 3388
    s_load_dwordx2 s[82:83], s[80:81], 3516
    v_sub_f32 v86, v86, v116
    v_sub_f32 v87, v87, v116
    v_sub_f32 v88, v88, v116
    v_sub_f32 v89, v89, v116
    buffer_load_dwordx4 v5, s[8:11], s72 offen offset:1024 lds
    v_sub_f32 v90, v90, v116
    v_sub_f32 v91, v91, v116
    v_sub_f32 v92, v92, v116
    v_sub_f32 v93, v93, v116
    v_sub_f32 v94, v94, v116
    v_sub_f32 v95, v95, v116
    v_sub_f32 v96, v96, v116
    v_sub_f32 v97, v97, v116
    buffer_load_dwordx4 v6, s[8:11], s72 offen offset:2048 lds
    v_sub_f32 v98, v98, v116
    v_sub_f32 v99, v99, v116
    v_sub_f32 v100, v100, v116
    v_sub_f32 v101, v101, v116
    v_sub_f32 v102, v102, v116
    v_sub_f32 v103, v103, v116
    v_sub_f32 v104, v104, v116
    buffer_load_dwordx4 v7, s[8:11], s72 offen offset:3072 lds
    v_sub_f32 v105, v105, v116
    v_sub_f32 v106, v106, v116
    v_sub_f32 v107, v107, v116
    v_sub_f32 v108, v108, v116
    v_sub_f32 v109, v109, v116
    v_sub_f32 v110, v110, v116
    v_sub_f32 v111, v111, v116
    v_mul_f32 v112, v48, v48
    s_add_u32 m0, s71, 115712
    s_mov_b32 exec_hi, s101
    buffer_load_dwordx4 v8, s[12:15], s73 offen offset:0 lds
    buffer_load_dwordx4 v9, s[12:15], s73 offen offset:896 lds
    s_mov_b32 exec_hi, -1
    v_mul_f32 v113, v49, v49
    v_mul_f32 v114, v50, v50
    v_mul_f32 v115, v51, v51
    v_fmac_f32 v112, v52, v52
    v_fmac_f32 v113, v53, v53
    v_fmac_f32 v114, v54, v54
    v_fmac_f32 v115, v55, v55
    v_fmac_f32 v112, v56, v56
    s_mov_b32 exec_hi, s101
    buffer_load_dwordx4 v10, s[12:15], s73 offen offset:1792 lds
    buffer_load_dwordx4 v11, s[12:15], s73 offen offset:2688 lds
    s_mov_b32 exec_hi, -1
    v_fmac_f32 v113, v57, v57
    v_fmac_f32 v114, v58, v58
    v_fmac_f32 v115, v59, v59
    v_fmac_f32 v112, v60, v60
    v_fmac_f32 v113, v61, v61
    v_fmac_f32 v114, v62, v62
    v_fmac_f32 v115, v63, v63
    s_add_u32 m0, s71, 119296
    s_mov_b32 exec_hi, s101
    buffer_load_dwordx4 v12, s[12:15], s73 offen offset:0 lds
    buffer_load_dwordx4 v13, s[12:15], s73 offen offset:896 lds
    s_mov_b32 exec_hi, -1
    v_fmac_f32 v112, v64, v64
    v_fmac_f32 v113, v65, v65
    v_fmac_f32 v114, v66, v66
    v_fmac_f32 v115, v67, v67
    v_fmac_f32 v112, v68, v68
    v_fmac_f32 v113, v69, v69
    v_fmac_f32 v114, v70, v70
    v_fmac_f32 v115, v71, v71
    s_mov_b32 exec_hi, s101
    buffer_load_dwordx4 v14, s[12:15], s73 offen offset:1792 lds
    buffer_load_dwordx4 v15, s[12:15], s73 offen offset:2688 lds
    s_mov_b32 exec_hi, -1
    v_fmac_f32 v112, v72, v72
    v_fmac_f32 v113, v73, v73
    v_fmac_f32 v114, v74, v74
    v_fmac_f32 v115, v75, v75
    v_fmac_f32 v112, v76, v76
    v_fmac_f32 v113, v77, v77
    v_fmac_f32 v114, v78, v78
    s_waitcnt vmcnt(12)
    s_barrier
    s_bfe_u32 s63, s87, 0x40004
    s_add_u32 m0, s70, 0
    s_lshl_b32 s72, s63, 7
    buffer_load_dwordx4 v4, s[8:11], s72 offen offset:0 lds
    s_mul_i32 s73, s63, 458752
    s_load_dwordx2 s[82:83], s[80:81], 3644
    s_load_dwordx2 s[82:83], s[80:81], 3772
    s_load_dwordx2 s[82:83], s[80:81], 3900
    s_load_dwordx2 s[82:83], s[80:81], 4028
    v_fmac_f32 v115, v79, v79
    v_fmac_f32 v112, v80, v80
    v_fmac_f32 v113, v81, v81
    v_fmac_f32 v114, v82, v82
    buffer_load_dwordx4 v5, s[8:11], s72 offen offset:1024 lds
    v_fmac_f32 v115, v83, v83
    v_fmac_f32 v112, v84, v84
    v_fmac_f32 v113, v85, v85
    v_fmac_f32 v114, v86, v86
    v_fmac_f32 v115, v87, v87
    v_fmac_f32 v112, v88, v88
    v_fmac_f32 v113, v89, v89
    buffer_load_dwordx4 v6, s[8:11], s72 offen offset:2048 lds
    v_fmac_f32 v114, v90, v90
    v_fmac_f32 v115, v91, v91
    v_fmac_f32 v112, v92, v92
    v_fmac_f32 v113, v93, v93
    v_fmac_f32 v114, v94, v94
    v_fmac_f32 v115, v95, v95
    v_fmac_f32 v112, v96, v96
    buffer_load_dwordx4 v7, s[8:11], s72 offen offset:3072 lds
    v_fmac_f32 v113, v97, v97
    v_fmac_f32 v114, v98, v98
    v_fmac_f32 v115, v99, v99
    v_fmac_f32 v112, v100, v100
    v_fmac_f32 v113, v101, v101
    v_fmac_f32 v114, v102, v102
    v_fmac_f32 v115, v103, v103
    s_add_u32 m0, s71, 0
    s_mov_b32 exec_hi, s101
    buffer_load_dwordx4 v8, s[12:15], s73 offen offset:0 lds
    buffer_load_dwordx4 v9, s[12:15], s73 offen offset:896 lds
    s_mov_b32 exec_hi, -1
    v_fmac_f32 v112, v104, v104
    v_fmac_f32 v113, v105, v105
    v_fmac_f32 v114, v106, v106
    v_fmac_f32 v115, v107, v107
    v_fmac_f32 v112, v108, v108
    v_fmac_f32 v113, v109, v109
    v_fmac_f32 v114, v110, v110
    v_fmac_f32 v115, v111, v111
    s_mov_b32 exec_hi, s101
    buffer_load_dwordx4 v10, s[12:15], s73 offen offset:1792 lds
    buffer_load_dwordx4 v11, s[12:15], s73 offen offset:2688 lds
    s_mov_b32 exec_hi, -1
    v_add_f32 v112, v112, v113
    v_add_f32 v114, v114, v115
    v_add_f32 v117, v112, v114
    s_nop 1
    v_add_f32_dpp v117, v117, v117 row_ror:8 row_mask:0xf bank_mask:0xf
    s_nop 1
    v_add_f32_dpp v117, v117, v117 row_ror:4 row_mask:0xf bank_mask:0xf
    s_nop 1
    v_add_f32_dpp v117, v117, v117 row_ror:2 row_mask:0xf bank_mask:0xf
    s_nop 1
    v_add_f32_dpp v117, v117, v117 row_ror:1 row_mask:0xf bank_mask:0xf
    s_add_u32 m0, s71, 3584
    s_mov_b32 exec_hi, s101
    buffer_load_dwordx4 v12, s[12:15], s73 offen offset:0 lds
    buffer_load_dwordx4 v13, s[12:15], s73 offen offset:896 lds
    s_mov_b32 exec_hi, -1
    v_mul_f32 v117, 0x3a800000, v117
    v_cvt_pk_bf16_f32 v112, v116, v117
    v_lshlrev_b32 v116, 16, v112
    v_and_b32 v117, 0xffff0000, v112
    v_add_f32 v117, 0x3727c5ac, v117
    v_cvt_pk_bf16_f32 v117, v117, v117
    v_lshlrev_b32 v117, 16, v117
    s_mov_b32 exec_hi, s101
    buffer_load_dwordx4 v14, s[12:15], s73 offen offset:1792 lds
    buffer_load_dwordx4 v15, s[12:15], s73 offen offset:2688 lds
    s_mov_b32 exec_hi, -1
    v_sqrt_f32 v117, v117
    v_mov_b32 v118, s94
    v_cvt_pk_bf16_f32 v117, v117, v117
    v_lshlrev_b32 v117, 16, v117
    v_mov_b32 v119, s95
    v_and_b32 v2, 48, v1
    s_lshl_b32 s60, s2, 7
    s_lshl_b32 s61, s32, 6
    s_add_u32 s60, s60, s61
    s_mov_b32 exec_lo, 0x00010001
    s_mov_b32 exec_hi, 0x00010001
    buffer_store_dwordx4 v[116:119], v2, s[16:19], s60 offen sc1
    s_mov_b64 exec, -1
    s_waitcnt vmcnt(13)
    s_barrier
    s_bfe_u32 s63, s87, 0x40008
    s_add_u32 m0, s70, 70656
    s_lshl_b32 s72, s63, 7
    buffer_load_dwordx4 v4, s[8:11], s72 offen offset:0 lds
    s_mul_i32 s73, s63, 458752
    s_load_dwordx2 s[82:83], s[80:81], 4156
    buffer_load_dwordx4 v5, s[8:11], s72 offen offset:1024 lds
    buffer_load_dwordx4 v6, s[8:11], s72 offen offset:2048 lds
    s_load_dwordx2 s[82:83], s[80:81], 4284
    buffer_load_dwordx4 v7, s[8:11], s72 offen offset:3072 lds
    s_add_u32 m0, s71, 70656
    s_mov_b32 exec_hi, s101
    buffer_load_dwordx4 v8, s[12:15], s73 offen offset:0 lds
    buffer_load_dwordx4 v9, s[12:15], s73 offen offset:896 lds
    s_mov_b32 exec_hi, -1
    s_load_dwordx2 s[82:83], s[80:81], 4412
    s_mov_b32 exec_hi, s101
    buffer_load_dwordx4 v10, s[12:15], s73 offen offset:1792 lds
    buffer_load_dwordx4 v11, s[12:15], s73 offen offset:2688 lds
    s_mov_b32 exec_hi, -1
    s_add_u32 m0, s71, 74240
    s_mov_b32 exec_hi, s101
    buffer_load_dwordx4 v12, s[12:15], s73 offen offset:0 lds
    buffer_load_dwordx4 v13, s[12:15], s73 offen offset:896 lds
    s_mov_b32 exec_hi, -1
    s_load_dwordx2 s[82:83], s[80:81], 4540
    s_mov_b32 exec_hi, s101
    buffer_load_dwordx4 v14, s[12:15], s73 offen offset:1792 lds
    buffer_load_dwordx4 v15, s[12:15], s73 offen offset:2688 lds
    s_mov_b32 exec_hi, -1
    s_mov_b32 s24, s44
    s_mov_b32 s25, s45
    s_mov_b32 s26, 0x400000
    s_mov_b32 s27, 0x20000
    v_lshlrev_b32 v2, 4, v1
    buffer_load_dwordx4 v[232:235], v2, s[24:27], s69 offen offset:0 nt
    buffer_load_dwordx4 v[236:239], v2, s[24:27], s69 offen offset:1024 nt
    buffer_load_dwordx4 v[240:243], v2, s[24:27], s69 offen offset:2048 nt
    buffer_load_dwordx4 v[244:247], v2, s[24:27], s69 offen offset:3072 nt
    s_waitcnt vmcnt(17)
    s_barrier
    s_bfe_u32 s63, s87, 0x4000c
    s_add_u32 m0, s70, 115712
    s_lshl_b32 s72, s63, 7
    buffer_load_dwordx4 v4, s[8:11], s72 offen offset:0 lds
    s_mul_i32 s73, s63, 458752
    s_load_dwordx2 s[82:83], s[80:81], 4668
    s_load_dwordx2 s[82:83], s[80:81], 4796
    s_load_dwordx2 s[82:83], s[80:81], 4924
    s_load_dwordx2 s[82:83], s[80:81], 5052
    v_mov_b32 v160, 0
    buffer_load_dwordx4 v5, s[8:11], s72 offen offset:1024 lds
    v_mov_b32 v161, 0
    v_mov_b32 v162, 0
    v_mov_b32 v163, 0
    v_mov_b32 v164, 0
    buffer_load_dwordx4 v6, s[8:11], s72 offen offset:2048 lds
    v_mov_b32 v165, 0
    v_mov_b32 v166, 0
    v_mov_b32 v167, 0
    v_mov_b32 v168, 0
    v_mov_b32 v169, 0
    buffer_load_dwordx4 v7, s[8:11], s72 offen offset:3072 lds
    v_mov_b32 v170, 0
    v_mov_b32 v171, 0
    v_mov_b32 v172, 0
    v_mov_b32 v173, 0
    s_add_u32 m0, s71, 115712
    s_mov_b32 exec_hi, s101
    buffer_load_dwordx4 v8, s[12:15], s73 offen offset:0 lds
    buffer_load_dwordx4 v9, s[12:15], s73 offen offset:896 lds
    s_mov_b32 exec_hi, -1
    v_mov_b32 v174, 0
    v_mov_b32 v175, 0
    v_mov_b32 v176, 0
    v_mov_b32 v177, 0
    v_mov_b32 v178, 0
    s_mov_b32 exec_hi, s101
    buffer_load_dwordx4 v10, s[12:15], s73 offen offset:1792 lds
    buffer_load_dwordx4 v11, s[12:15], s73 offen offset:2688 lds
    s_mov_b32 exec_hi, -1
    v_mov_b32 v179, 0
    v_mov_b32 v180, 0
    v_mov_b32 v181, 0
    v_mov_b32 v182, 0
    s_add_u32 m0, s71, 119296
    s_mov_b32 exec_hi, s101
    buffer_load_dwordx4 v12, s[12:15], s73 offen offset:0 lds
    buffer_load_dwordx4 v13, s[12:15], s73 offen offset:896 lds
    s_mov_b32 exec_hi, -1
    v_mov_b32 v183, 0
    v_mov_b32 v184, 0
    v_mov_b32 v185, 0
    v_mov_b32 v186, 0
    v_mov_b32 v187, 0
    s_mov_b32 exec_hi, s101
    buffer_load_dwordx4 v14, s[12:15], s73 offen offset:1792 lds
    buffer_load_dwordx4 v15, s[12:15], s73 offen offset:2688 lds
    s_mov_b32 exec_hi, -1
    v_mov_b32 v188, 0
    v_mov_b32 v189, 0
    v_mov_b32 v190, 0
    v_mov_b32 v191, 0
    s_waitcnt vmcnt(16)
    s_barrier
    s_bfe_u32 s63, s87, 0x40010
    s_add_u32 m0, s70, 0
    s_lshl_b32 s72, s63, 7
    buffer_load_dwordx4 v4, s[8:11], s72 offen offset:0 lds
    s_mul_i32 s73, s63, 458752
    s_load_dwordx2 s[82:83], s[80:81], 5180
    s_load_dwordx2 s[82:83], s[80:81], 5308
    s_load_dwordx2 s[82:83], s[80:81], 5436
    s_load_dwordx2 s[82:83], s[80:81], 5564
    buffer_load_dwordx4 v5, s[8:11], s72 offen offset:1024 lds
    s_mul_i32 s60, s33, 20224
    s_add_u32 s60, s60, 79872
    v_lshlrev_b32 v196, 4, v1
    v_add_u32 v197, s60, v196
    v_lshrrev_b32 v2, 4, v1
    v_lshl_add_u32 v198, v2, 5, v197
    v_and_b32 v3, 15, v1
    v_add_u32 v199, v3, v2
    v_lshl_add_u32 v199, v199, 4, s60
    v_bfe_u32 v206, v1, 2, 2
    v_sub_u32 v211, 3, v206
    v_mul_u32_u24 v211, 288, v211
    v_add_u32 v211, s60, v211
    s_lshl_b32 s61, s32, 15
    s_add_u32 s62, s6, s61
    v_lshlrev_b32 v204, 1, v2
    v_xor_b32 v204, v204, v1
    v_and_b32 v204, 7, v204
    v_lshl_add_u32 v204, v204, 4, s62
    v_lshrrev_b32 v3, 3, v3
    v_mul_u32_u24 v3, s7, v3
    v_xor_b32 v3, v3, v204
    v_lshl_add_u32 v200, v2, 11, v3
    v_xor_b32 v3, s7, v200
    v_add_u32 v201, 7168, v3
    buffer_load_dwordx4 v6, s[8:11], s72 offen offset:2048 lds
    v_add_u32 v202, 14336, v200
    v_add_u32 v203, 21504, v3
    v_lshrrev_b32 v3, 3, v1
    v_lshl_add_u32 v204, v3, 11, v204
    buffer_load_dwordx4 v7, s[8:11], s72 offen offset:3072 lds
    v_add_u32 v205, 15360, v204
    v_and_b32 v3, 3, v1
    v_lshlrev_b32 v207, 6, v2
    v_lshl_add_u32 v206, v206, 8, v207
    s_add_u32 m0, s71, 0
    s_mov_b32 exec_hi, s101
    buffer_load_dwordx4 v8, s[12:15], s73 offen offset:0 lds
    buffer_load_dwordx4 v9, s[12:15], s73 offen offset:896 lds
    s_mov_b32 exec_hi, -1
    v_lshl_add_u32 v206, v3, 4, v206
    v_lshl_add_u32 v211, v2, 4, v211
    v_and_b32 v2, 1, v1
    v_sub_u32 v2, 1, v2
    s_mov_b32 exec_hi, s101
    buffer_load_dwordx4 v10, s[12:15], s73 offen offset:1792 lds
    buffer_load_dwordx4 v11, s[12:15], s73 offen offset:2688 lds
    s_mov_b32 exec_hi, -1
    v_mul_u32_u24 v2, 5760, v2
    v_bfe_u32 v3, v1, 1, 1
    v_sub_u32 v3, 1, v3
    v_lshlrev_b32 v3, 3, v3
    s_add_u32 m0, s71, 3584
    s_mov_b32 exec_hi, s101
    buffer_load_dwordx4 v12, s[12:15], s73 offen offset:0 lds
    buffer_load_dwordx4 v13, s[12:15], s73 offen offset:896 lds
    s_mov_b32 exec_hi, -1
    v_add3_u32 v211, v211, v2, v3
    v_and_b32 v2, 50, v1
    v_add_u32 v3, 32, v211
    v_cmp_eq_u32 vcc, 48, v2
    s_nop 1
    v_cndmask_b32 v207, v211, v3, vcc
    s_mov_b32 exec_hi, s101
    buffer_load_dwordx4 v14, s[12:15], s73 offen offset:1792 lds
    buffer_load_dwordx4 v15, s[12:15], s73 offen offset:2688 lds
    s_mov_b32 exec_hi, -1
    v_and_b32 v212, 3, v1
    v_lshlrev_b32 v212, 2, v212
    v_add_u32 v212, 161664, v212
    s_waitcnt vmcnt(12)
    s_barrier
    s_bfe_u32 s63, s87, 0x40014
    s_add_u32 m0, s70, 70656
    s_lshl_b32 s72, s63, 7
    buffer_load_dwordx4 v4, s[8:11], s72 offen offset:0 lds
    s_mul_i32 s73, s63, 458752
    s_load_dwordx2 s[82:83], s[80:81], 5692
    buffer_load_dwordx4 v5, s[8:11], s72 offen offset:1024 lds
    s_load_dwordx2 s[82:83], s[80:81], 5820
    buffer_load_dwordx4 v6, s[8:11], s72 offen offset:2048 lds
    s_load_dwordx2 s[82:83], s[80:81], 5948
    buffer_load_dwordx4 v7, s[8:11], s72 offen offset:3072 lds
    s_add_u32 m0, s71, 70656
    s_mov_b32 exec_hi, s101
    buffer_load_dwordx4 v8, s[12:15], s73 offen offset:0 lds
    buffer_load_dwordx4 v9, s[12:15], s73 offen offset:896 lds
    s_mov_b32 exec_hi, -1
    s_load_dwordx2 s[82:83], s[80:81], 6076
    s_mov_b32 exec_hi, s101
    buffer_load_dwordx4 v10, s[12:15], s73 offen offset:1792 lds
    buffer_load_dwordx4 v11, s[12:15], s73 offen offset:2688 lds
    s_mov_b32 exec_hi, -1
    v_min_u32 v122, 31, v1
    v_lshlrev_b32 v122, 3, v122
    s_add_u32 m0, s71, 74240
    s_mov_b32 exec_hi, s101
    buffer_load_dwordx4 v12, s[12:15], s73 offen offset:0 lds
    buffer_load_dwordx4 v13, s[12:15], s73 offen offset:896 lds
    s_mov_b32 exec_hi, -1
    s_lshr_b32 s74, s2, 4
    s_lshl_b32 s74, s74, 8
    s_add_u32 s74, s74, 8192
    s_lshl_b32 s75, s5, 8
    s_add_u32 s75, s75, 4096
    s_mov_b32 exec_hi, s101
    buffer_load_dwordx4 v14, s[12:15], s73 offen offset:1792 lds
    buffer_load_dwordx4 v15, s[12:15], s73 offen offset:2688 lds
    s_mov_b32 exec_hi, -1
    s_waitcnt vmcnt(12)
    s_barrier
    s_bfe_u32 s63, s87, 0x40018
    s_add_u32 m0, s70, 115712
    s_lshl_b32 s72, s63, 7
    buffer_load_dwordx4 v4, s[8:11], s72 offen offset:0 lds
    s_mul_i32 s73, s63, 458752
    s_load_dwordx2 s[82:83], s[80:81], 6204
    s_load_dwordx2 s[82:83], s[80:81], 6332
    s_load_dwordx2 s[82:83], s[80:81], 6460
    buffer_load_dwordx4 v5, s[8:11], s72 offen offset:1024 lds
    s_load_dwordx2 s[82:83], s[80:81], 6588
    v_and_b32 v2, 31, v1
    buffer_load_dwordx4 v6, s[8:11], s72 offen offset:2048 lds
    v_min_u32 v123, 27, v2
    v_lshrrev_b32 v3, 5, v1
    buffer_load_dwordx4 v7, s[8:11], s72 offen offset:3072 lds
    s_mov_b32 s60, 114688
    v_mul_lo_u32 v3, v3, s60
    s_add_u32 m0, s71, 115712
    s_mov_b32 exec_hi, s101
    buffer_load_dwordx4 v8, s[12:15], s73 offen offset:0 lds
    buffer_load_dwordx4 v9, s[12:15], s73 offen offset:896 lds
    s_mov_b32 exec_hi, -1
    v_lshl_add_u32 v125, v123, 4, v3
    s_mul_i32 s65, s5, 896
    s_mov_b32 exec_hi, s101
    buffer_load_dwordx4 v10, s[12:15], s73 offen offset:1792 lds
    buffer_load_dwordx4 v11, s[12:15], s73 offen offset:2688 lds
    s_mov_b32 exec_hi, -1
    s_mul_i32 s61, s32, 448
    s_add_u32 s65, s65, s61
    s_add_u32 m0, s71, 119296
    s_mov_b32 exec_hi, s101
    buffer_load_dwordx4 v12, s[12:15], s73 offen offset:0 lds
    buffer_load_dwordx4 v13, s[12:15], s73 offen offset:896 lds
    s_mov_b32 exec_hi, -1
    s_lshl_b32 s66, s4, 11
    s_lshl_b32 s60, s32, 10
    s_mov_b32 exec_hi, s101
    buffer_load_dwordx4 v14, s[12:15], s73 offen offset:1792 lds
    buffer_load_dwordx4 v15, s[12:15], s73 offen offset:2688 lds
    s_mov_b32 exec_hi, -1
    s_add_u32 s66, s66, s60
    v_lshlrev_b32 v124, 4, v1
    buffer_load_dwordx2 v[18:19], v122, s[28:31], s75 offen sc1
    s_waitcnt vmcnt(13)
    s_barrier
    s_bfe_u32 s63, s87, 0x4001c
    s_add_u32 m0, s70, 0
    s_lshl_b32 s72, s63, 7
    buffer_load_dwordx4 v4, s[8:11], s72 offen offset:0 lds
    s_mul_i32 s73, s63, 458752
    s_load_dwordx2 s[82:83], s[80:81], 6716
    s_load_dwordx2 s[82:83], s[80:81], 6844
    s_load_dwordx2 s[82:83], s[80:81], 6972
    buffer_load_dwordx4 v5, s[8:11], s72 offen offset:1024 lds
    s_load_dwordx2 s[82:83], s[80:81], 7100
    s_lshr_b32 s60, s67, 16
    s_and_b32 s61, s68, 1
    s_cmp_eq_u32 s61, 1
    s_cselect_b32 s60, s60, s67
    s_lshl_b32 s60, s60, 16
    s_mov_b64 exec, 1
    v_lshlrev_b32 v2, 16, v232
    v_and_b32 v3, 0xffff0000, v232
    v_add_f32 v2, s60, v2
    v_cvt_pk_bf16_f32 v232, v2, v3
    s_mov_b64 exec, -1
    buffer_load_dwordx4 v6, s[8:11], s72 offen offset:2048 lds
    v_mov_b32_dpp v2, v235 wave_shr:1 row_mask:0xf bank_mask:0xf bound_ctrl:0
    v_alignbit_b32 v128, v232, v2, 16
    v_alignbit_b32 v129, v233, v232, 16
    v_alignbit_b32 v130, v234, v233, 16
    buffer_load_dwordx4 v7, s[8:11], s72 offen offset:3072 lds
    v_alignbit_b32 v131, v235, v234, 16
    v_mov_b32_dpp v2, v239 wave_shr:1 row_mask:0xf bank_mask:0xf bound_ctrl:0
    v_readlane_b32 s61, v235, 63
    s_nop 3
    v_writelane_b32 v2, s61, 0
    v_alignbit_b32 v132, v236, v2, 16
    v_alignbit_b32 v133, v237, v236, 16
    s_add_u32 m0, s71, 0
    s_mov_b32 exec_hi, s101
    buffer_load_dwordx4 v8, s[12:15], s73 offen offset:0 lds
    buffer_load_dwordx4 v9, s[12:15], s73 offen offset:896 lds
    s_mov_b32 exec_hi, -1
    v_alignbit_b32 v134, v238, v237, 16
    v_alignbit_b32 v135, v239, v238, 16
    v_mov_b32_dpp v2, v243 wave_shr:1 row_mask:0xf bank_mask:0xf bound_ctrl:0
    v_readlane_b32 s61, v239, 63
    s_nop 3
    v_writelane_b32 v2, s61, 0
    v_alignbit_b32 v136, v240, v2, 16
    s_mov_b32 exec_hi, s101
    buffer_load_dwordx4 v10, s[12:15], s73 offen offset:1792 lds
    buffer_load_dwordx4 v11, s[12:15], s73 offen offset:2688 lds
    s_mov_b32 exec_hi, -1
    v_alignbit_b32 v137, v241, v240, 16
    v_alignbit_b32 v138, v242, v241, 16
    v_alignbit_b32 v139, v243, v242, 16
    s_add_u32 m0, s71, 3584
    s_mov_b32 exec_hi, s101
    buffer_load_dwordx4 v12, s[12:15], s73 offen offset:0 lds
    buffer_load_dwordx4 v13, s[12:15], s73 offen offset:896 lds
    s_mov_b32 exec_hi, -1
    v_mov_b32_dpp v2, v247 wave_shr:1 row_mask:0xf bank_mask:0xf bound_ctrl:0
    v_readlane_b32 s61, v243, 63
    s_nop 3
    v_writelane_b32 v2, s61, 0
    v_alignbit_b32 v140, v244, v2, 16
    v_alignbit_b32 v141, v245, v244, 16
    v_alignbit_b32 v142, v246, v245, 16
    s_mov_b32 exec_hi, s101
    buffer_load_dwordx4 v14, s[12:15], s73 offen offset:1792 lds
    buffer_load_dwordx4 v15, s[12:15], s73 offen offset:2688 lds
    s_mov_b32 exec_hi, -1
    v_alignbit_b32 v143, v247, v246, 16
    s_lshr_b32 s74, s2, 4
    s_lshl_b32 s74, s74, 8
    s_add_u32 s74, s74, 8192
    v_min_u32 v210, 31, v1
    v_lshlrev_b32 v210, 3, v210
    v_and_b32 v213, 255, v196
    buffer_load_dwordx4 v[192:195], v213, s[28:31], s74 offen sc1
    s_waitcnt vmcnt(13)
    v_cmp_ne_u64 vcc, s[94:95], v[18:19]
    s_cbranch_vccz L_rpok_2
    s_mov_b32 s62, 200000
L_rp_1:
    s_sleep 4
    buffer_load_dwordx2 v[18:19], v122, s[28:31], s75 offen sc1
    s_waitcnt vmcnt(0)
    v_cmp_ne_u64 vcc, s[94:95], v[18:19]
    s_cbranch_vccz L_rpok_2
    s_sub_u32 s62, s62, 1
    s_cmp_lg_u32 s62, 0
    s_cbranch_scc1 L_rp_1
L_rpok_2:
    buffer_load_dwordx4 v[32:35], v125, s[20:23], s65 offen sc1
    s_add_u32 s65, s65, 14336
    buffer_load_dwordx4 v[36:39], v125, s[20:23], s65 offen sc1
    s_add_u32 s65, s65, 14336
    buffer_load_dwordx4 v[40:43], v125, s[20:23], s65 offen sc1
    s_add_u32 s65, s65, 14336
    buffer_load_dwordx4 v[44:47], v125, s[20:23], s65 offen sc1
    s_add_u32 s65, s65, 14336
    buffer_load_dwordx4 v[48:51], v125, s[20:23], s65 offen sc1
    s_add_u32 s65, s65, 14336
    buffer_load_dwordx4 v[52:55], v125, s[20:23], s65 offen sc1
    s_add_u32 s65, s65, 14336
    buffer_load_dwordx4 v[56:59], v125, s[20:23], s65 offen sc1
    s_add_u32 s65, s65, 14336
    buffer_load_dwordx4 v[60:63], v125, s[20:23], s65 offen sc1
    s_add_u32 s65, s65, 14336
    s_barrier
    s_lshl_b32 s60, s4, 18
    s_lshl_b32 s61, s32, 17
    s_add_u32 s60, s60, s61
    s_add_u32 s60, s60, s6
    s_lshr_b32 s61, s33, 1
    s_lshl_b32 s61, s61, 6
    s_add_u32 s60, s60, s61
    v_lshrrev_b32 v2, 2, v1
    v_and_b32 v3, 3, v1
    v_lshlrev_b32 v3, 4, v3
    v_lshl_add_u32 v2, v2, 11, v3
    s_add_u32 m0, s70, 49152
    s_add_u32 s61, s60, 0
    buffer_load_dwordx4 v2, s[8:11], s61 offen offset:0 lds
    s_add_u32 s61, s60, 31744
    buffer_load_dwordx4 v2, s[8:11], s61 offen offset:1024 lds
    s_add_u32 s61, s60, 63488
    buffer_load_dwordx4 v2, s[8:11], s61 offen offset:2048 lds
    s_add_u32 s61, s60, 95232
    buffer_load_dwordx4 v2, s[8:11], s61 offen offset:3072 lds
    buffer_load_dwordx4 v[24:27], v124, s[16:19], s66 offen sc1
    s_waitcnt vmcnt(5)
    v_add_f32 v32, v32, v36
    v_add_f32 v33, v33, v37
    v_add_f32 v34, v34, v38
    v_add_f32 v35, v35, v39
    v_add_f32 v32, v32, v40
    v_add_f32 v33, v33, v41
    v_add_f32 v34, v34, v42
    v_add_f32 v35, v35, v43
    v_add_f32 v32, v32, v44
    v_add_f32 v33, v33, v45
    v_add_f32 v34, v34, v46
    v_add_f32 v35, v35, v47
    v_add_f32 v32, v32, v48
    v_add_f32 v33, v33, v49
    v_add_f32 v34, v34, v50
    v_add_f32 v35, v35, v51
    v_add_f32 v32, v32, v52
    v_add_f32 v33, v33, v53
    v_add_f32 v34, v34, v54
    v_add_f32 v35, v35, v55
    v_add_f32 v32, v32, v56
    v_add_f32 v33, v33, v57
    v_add_f32 v34, v34, v58
    v_add_f32 v35, v35, v59
    v_add_f32 v32, v32, v60
    v_add_f32 v33, v33, v61
    v_add_f32 v34, v34, v62
    v_add_f32 v35, v35, v63
    v_mov_b32 v36, v32
    v_mov_b32 v37, v33
    v_mov_b32 v38, v34
    v_mov_b32 v39, v35
    s_nop 1
    v_permlane32_swap_b32 v32, v36
    v_permlane32_swap_b32 v33, v37
    v_permlane32_swap_b32 v34, v38
    v_permlane32_swap_b32 v35, v39
    s_mul_i32 s61, s32, 448
    s_add_u32 s61, s61, 160768
    v_add_f32 v32, v32, v36
    v_add_f32 v33, v33, v37
    v_add_f32 v34, v34, v38
    v_add_f32 v35, v35, v39
    v_lshl_add_u32 v123, v123, 4, s61
    s_barrier
    v_cmp_ne_u64 vcc, s[94:95], v[192:193]
    v_cmp_ne_u64 s[60:61], s[94:95], v[194:195]
    s_or_b64 vcc, vcc, s[60:61]
    s_cselect_b32 s35, 1, 0
    s_add_u32 s24, s58, 0x1000000
    s_addc_u32 s25, s59, 0
    s_mov_b32 s26, 0x400000
    s_mov_b32 s27, 0x20000
    s_lshl_b32 s64, s2, 14
    s_lshl_b32 s61, s33, 4
    s_add_u32 s64, s64, s61
    v_lshlrev_b32 v2, 6, v1
    buffer_load_dwordx4 v[216:219], v2, s[24:27], s64 offen sc1
    s_add_u32 s64, s64, 4096
    buffer_load_dwordx4 v[220:223], v2, s[24:27], s64 offen sc1
    s_add_u32 s64, s64, 4096
    buffer_load_dwordx4 v[224:227], v2, s[24:27], s64 offen sc1
    s_add_u32 s64, s64, 4096
    buffer_load_dwordx4 v[228:231], v2, s[24:27], s64 offen sc1
    s_add_u32 s64, s64, 4096
    s_waitcnt vmcnt(5)
    ds_write_b128 v123, v[32:35]
    s_waitcnt vmcnt(4)
    v_cmp_ne_u64 vcc, s[94:95], v[26:27]
    s_cbranch_vccz L_rpok_4
    s_mov_b32 s62, 200000
L_rp_3:
    s_sleep 4
    buffer_load_dwordx4 v[24:27], v124, s[16:19], s66 offen sc1
    s_waitcnt vmcnt(0)
    v_cmp_ne_u64 vcc, s[94:95], v[26:27]
    s_cbranch_vccz L_rpok_4
    s_sub_u32 s62, s62, 1
    s_cmp_lg_u32 s62, 0
    s_cbranch_scc1 L_rp_3
L_rpok_4:
    v_rcp_f32 v27, v25
    s_lshl_b32 s60, s32, 10
    s_add_u32 s60, s60, 161792
    v_add_u32 v124, s60, v124
    v_mul_f32 v26, 0xbfb8aa3b, v27
    ds_write_b128 v124, v[24:27]
L_conv_start:
    ds_write_b128 v197, v[160:163] offset:0
    ds_write_b128 v197, v[160:163] offset:4352
    ds_write_b128 v197, v[160:163] offset:13280
    ds_write_b128 v197, v[160:163] offset:13440
    s_add_u32 s16, s58, 0x1400000
    s_addc_u32 s17, s59, 0
    s_mov_b32 s18, 0x400000
    s_mov_b32 s19, 0x20000
    s_mov_b32 s12, s52
    s_mov_b32 s13, s53
    s_mov_b32 s14, 0x700000
    s_mov_b32 s15, 0x20000
    s_mov_b32 s8, s58
    s_mov_b32 s9, s59
    s_mov_b32 s10, 0xe00000
    s_mov_b32 s11, 0x20000
    s_and_b32 s76, s5, 8
    s_and_b32 s72, s5, 7
    s_lshr_b32 s73, s33, 1
    s_lshl_b32 s77, s33, 12
    s_lshl_b32 s60, s4, 4
    s_add_u32 s79, s60, s76
    s_mul_i32 s79, s79, 49152
    s_add_u32 s79, s79, s77
    s_lshl_b32 s71, s4, 17
    s_lshl_b32 s60, s32, 12
    s_add_u32 s71, s71, s60
    s_add_u32 s71, s71, 12582912
    s_lshl_b32 s78, s33, 11
    s_mul_i32 s34, s76, 7
    s_lshl_b32 s60, s73, 2
    s_add_u32 s34, s34, s60
    s_lshl_b32 s85, s72, 0
    s_lshr_b32 s60, s84, 8
    s_add_u32 s85, s85, s60
    s_add_u32 s85, s85, s73
    s_lshr_b32 s60, 0x0, s84
    s_bfe_u32 s61, s60, 0x20003
    s_add_u32 s60, s60, s72
    s_and_b32 s60, s60, 7
    s_mul_i32 s60, s60, 7
    s_add_u32 s60, s60, s61
    s_add_u32 s60, s60, s34
    s_lshl_b32 s75, s60, 16
    s_waitcnt lgkmcnt(4)
    s_barrier
    s_cmp_eq_u32 s35, 0
    s_cbranch_scc1 L_udone
    v_cmp_ne_u64 vcc, s[94:95], v[192:193]
    v_cmp_ne_u64 s[60:61], s[94:95], v[194:195]
    s_or_b64 vcc, vcc, s[60:61]
    s_cbranch_vccz L_rpok_6
    s_mov_b32 s62, 200000
L_rp_5:
    s_sleep 2
    buffer_load_dwordx4 v[192:195], v213, s[28:31], s74 offen sc1
    s_waitcnt vmcnt(0)
    v_cmp_ne_u64 vcc, s[94:95], v[192:193]
    v_cmp_ne_u64 s[60:61], s[94:95], v[194:195]
    s_or_b64 vcc, vcc, s[60:61]
    s_cbranch_vccz L_rpok_6
    s_sub_u32 s62, s62, 1
    s_cmp_lg_u32 s62, 0
    s_cbranch_scc1 L_rp_5
L_rpok_6:
    s_add_u32 s24, s58, 0x1000000
    s_addc_u32 s25, s59, 0
    s_mov_b32 s26, 0x400000
    s_mov_b32 s27, 0x20000
    s_lshl_b32 s64, s2, 14
    s_lshl_b32 s61, s33, 4
    s_add_u32 s64, s64, s61
    v_lshlrev_b32 v2, 6, v1
    buffer_load_dwordx4 v[216:219], v2, s[24:27], s64 offen sc1
    s_add_u32 s64, s64, 4096
    buffer_load_dwordx4 v[220:223], v2, s[24:27], s64 offen sc1
    s_add_u32 s64, s64, 4096
    buffer_load_dwordx4 v[224:227], v2, s[24:27], s64 offen sc1
    s_add_u32 s64, s64, 4096
    buffer_load_dwordx4 v[228:231], v2, s[24:27], s64 offen sc1
    s_add_u32 s64, s64, 4096
L_udone:
    s_add_u32 m0, s77, 0
    s_nop 0
    buffer_load_dwordx4 v200, s[12:15], s75 offen offset:0 lds
    buffer_load_dwordx4 v201, s[12:15], s75 offen offset:1024 lds
    buffer_load_dwordx4 v202, s[12:15], s75 offen offset:2048 lds
    buffer_load_dwordx4 v203, s[12:15], s75 offen offset:3072 lds
    s_lshr_b32 s60, 0x8080808, s84
    s_bfe_u32 s61, s60, 0x20003
    s_add_u32 s60, s60, s72
    s_and_b32 s60, s60, 7
    s_mul_i32 s60, s60, 7
    s_add_u32 s60, s60, s61
    s_add_u32 s60, s60, s34
    s_lshl_b32 s75, s60, 16
    s_add_u32 m0, s77, 32768
    s_nop 0
    buffer_load_dwordx4 v200, s[12:15], s75 offen offset:0 lds
    buffer_load_dwordx4 v201, s[12:15], s75 offen offset:1024 lds
    buffer_load_dwordx4 v202, s[12:15], s75 offen offset:2048 lds
    buffer_load_dwordx4 v203, s[12:15], s75 offen offset:3072 lds
    s_waitcnt vmcnt(8)
    v_mov_b32 v64, v217
    v_mov_b32 v65, v218
    v_mov_b32 v66, v219
    v_mov_b32_dpp v67, v216 wave_shl:1 row_mask:0xf bank_mask:0xf bound_ctrl:0
    v_readlane_b32 s60, v220, 0
    s_nop 1
    v_writelane_b32 v67, s60, 63
    v_mov_b32 v68, v221
    v_mov_b32 v69, v222
    v_mov_b32 v70, v223
    v_mov_b32_dpp v71, v220 wave_shl:1 row_mask:0xf bank_mask:0xf bound_ctrl:0
    v_readlane_b32 s60, v224, 0
    s_nop 1
    v_writelane_b32 v71, s60, 63
    v_mov_b32 v72, v225
    v_mov_b32 v73, v226
    v_mov_b32 v74, v227
    v_mov_b32_dpp v75, v224 wave_shl:1 row_mask:0xf bank_mask:0xf bound_ctrl:0
    v_readlane_b32 s60, v228, 0
    s_nop 1
    v_writelane_b32 v75, s60, 63
    v_mov_b32 v76, v229
    v_mov_b32 v77, v230
    v_mov_b32 v78, v231
    v_mov_b32_dpp v79, v228 wave_shl:1 row_mask:0xf bank_mask:0xf bound_ctrl:0
    ds_write_b128 v197, v[160:163] offset:19040
    ds_write_b128 v197, v[160:163] offset:19200
    ds_write_b128 v197, v[232:235] offset:4608
    ds_write_b128 v197, v[128:131] offset:256
    ds_write_b128 v197, v[236:239] offset:5632
    ds_write_b128 v197, v[132:135] offset:1280
    ds_write_b128 v197, v[240:243] offset:6656
    ds_write_b128 v197, v[136:139] offset:2304
    ds_write_b128 v197, v[244:247] offset:7680
    ds_write_b128 v197, v[140:143] offset:3328
    ds_write_b128 v198, v[216:219] offset:8704
    ds_write_b128 v198, v[64:67] offset:14464
    ds_write_b128 v198, v[220:223] offset:9856
    ds_write_b128 v198, v[68:71] offset:15616
    ds_write_b128 v198, v[224:227] offset:11008
    ds_write_b128 v198, v[72:75] offset:16768
    ds_write_b128 v198, v[228:231] offset:12160
    ds_write_b128 v198, v[76:79] offset:17920
    s_setprio 0
    s_waitcnt lgkmcnt(0)
    ds_read_b64 v[80:81], v211 offset:12160
    ds_read_b64 v[82:83], v211 offset:12168
    ds_read_b128 v[48:51], v199 offset:16
    ds_read_b128 v[52:55], v199 offset:4368
    ds_read_b64 v[84:85], v211 offset:11008
    ds_read_b64 v[86:87], v211 offset:11016
    ds_read_b64 v[88:89], v211 offset:9856
    ds_read_b64 v[90:91], v211 offset:9864
    ds_read_b64 v[92:93], v211 offset:8704
    ds_read_b64 v[94:95], v211 offset:8712
    ds_read_b128 v[56:59], v199 offset:1040
    ds_read_b128 v[60:63], v199 offset:5392
    ds_read_b128 v[64:67], v199 offset:2064
    ds_read_b128 v[68:71], v199 offset:6416
    ds_read_b128 v[72:75], v199 offset:3088
    ds_read_b128 v[76:79], v199 offset:7440
    s_lshr_b32 s60, 0x10101010, s84
    s_bfe_u32 s61, s60, 0x20003
    s_add_u32 s60, s60, s72
    s_and_b32 s60, s60, 7
    s_mul_i32 s74, s60, 3
    s_add_u32 s74, s74, s61
    s_lshl_b32 s74, s74, 14
    s_add_u32 s74, s74, s79
    s_mul_i32 s60, s60, 7
    s_add_u32 s60, s60, s61
    s_add_u32 s60, s60, s34
    s_lshl_b32 s75, s60, 16
    s_mov_b32 s62, 1000000
L_lw_7:
    ds_read_b32 v248, v212
    s_waitcnt lgkmcnt(0)
    v_cmp_gt_u32 vcc, 1, v248
    s_cbranch_vccz L_lwok_8
    s_sleep 1
    s_sub_u32 s62, s62, 1
    s_cmp_lg_u32 s62, 0
    s_cbranch_scc1 L_lw_7
L_lwok_8:
    s_setprio 0
    s_mov_b32 s64, 0
    .p2align 3
L_conv_loop:
    s_waitcnt lgkmcnt(0)
    s_nop 0
    v_mfma_f32_16x16x32_bf16 v[160:163], v[48:51], v[80:83], v[160:163]
    ds_read_b64 v[128:129], v211 offset:12224
    v_mfma_f32_16x16x32_bf16 v[164:167], v[52:55], v[80:83], v[164:167]
    ds_read_b64 v[130:131], v211 offset:12232
    v_mfma_f32_16x16x32_bf16 v[172:175], v[52:55], v[84:87], v[172:175]
    ds_read_b128 v[96:99], v199 offset:80
    v_mfma_f32_16x16x32_bf16 v[168:171], v[48:51], v[84:87], v[168:171]
    ds_read_b128 v[100:103], v199 offset:4432
    v_mfma_f32_16x16x32_bf16 v[176:179], v[48:51], v[88:91], v[176:179]
    ds_read_b64 v[132:133], v211 offset:11072
    v_mfma_f32_16x16x32_bf16 v[180:183], v[52:55], v[88:91], v[180:183]
    ds_read_b64 v[134:135], v211 offset:11080
    v_mfma_f32_16x16x32_bf16 v[188:191], v[52:55], v[92:95], v[188:191]
    ds_read_b64 v[136:137], v211 offset:9920
    v_mfma_f32_16x16x32_bf16 v[184:187], v[48:51], v[92:95], v[184:187]
    ds_read_b64 v[138:139], v211 offset:9928
    v_mfma_f32_16x16x32_bf16 v[168:171], v[56:59], v[80:83], v[168:171]
    ds_read_b64 v[140:141], v211 offset:8768
    v_mfma_f32_16x16x32_bf16 v[172:175], v[60:63], v[80:83], v[172:175]
    ds_read_b64 v[142:143], v211 offset:8776
    v_mfma_f32_16x16x32_bf16 v[180:183], v[60:63], v[84:87], v[180:183]
    ds_read_b128 v[104:107], v199 offset:1104
    v_mfma_f32_16x16x32_bf16 v[176:179], v[56:59], v[84:87], v[176:179]
    ds_read_b128 v[108:111], v199 offset:5456
    v_mfma_f32_16x16x32_bf16 v[184:187], v[56:59], v[88:91], v[184:187]
    ds_read_b128 v[112:115], v199 offset:2128
    v_mfma_f32_16x16x32_bf16 v[188:191], v[60:63], v[88:91], v[188:191]
    ds_read_b128 v[116:119], v199 offset:6480
    v_mfma_f32_16x16x32_bf16 v[176:179], v[64:67], v[80:83], v[176:179]
    ds_read_b128 v[120:123], v199 offset:3152
    v_mfma_f32_16x16x32_bf16 v[180:183], v[68:71], v[80:83], v[180:183]
    ds_read_b128 v[124:127], v199 offset:7504
    v_mfma_f32_16x16x32_bf16 v[188:191], v[68:71], v[84:87], v[188:191]
    v_mfma_f32_16x16x32_bf16 v[184:187], v[64:67], v[84:87], v[184:187]
    v_mfma_f32_16x16x32_bf16 v[184:187], v[72:75], v[80:83], v[184:187]
    v_mfma_f32_16x16x32_bf16 v[188:191], v[76:79], v[80:83], v[188:191]
    s_waitcnt lgkmcnt(0)
    s_nop 0
    v_mfma_f32_16x16x32_bf16 v[160:163], v[96:99], v[128:131], v[160:163]
    ds_read_b64 v[80:81], v211 offset:12288
    v_mfma_f32_16x16x32_bf16 v[164:167], v[100:103], v[128:131], v[164:167]
    ds_read_b64 v[82:83], v211 offset:12296
    v_mfma_f32_16x16x32_bf16 v[172:175], v[100:103], v[132:135], v[172:175]
    ds_read_b128 v[48:51], v199 offset:144
    v_mfma_f32_16x16x32_bf16 v[168:171], v[96:99], v[132:135], v[168:171]
    ds_read_b128 v[52:55], v199 offset:4496
    v_mfma_f32_16x16x32_bf16 v[176:179], v[96:99], v[136:139], v[176:179]
    ds_read_b64 v[84:85], v211 offset:11136
    v_mfma_f32_16x16x32_bf16 v[180:183], v[100:103], v[136:139], v[180:183]
    ds_read_b64 v[86:87], v211 offset:11144
    v_mfma_f32_16x16x32_bf16 v[188:191], v[100:103], v[140:143], v[188:191]
    ds_read_b64 v[88:89], v211 offset:9984
    v_mfma_f32_16x16x32_bf16 v[184:187], v[96:99], v[140:143], v[184:187]
    ds_read_b64 v[90:91], v211 offset:9992
    v_mfma_f32_16x16x32_bf16 v[168:171], v[104:107], v[128:131], v[168:171]
    ds_read_b64 v[92:93], v211 offset:8832
    v_mfma_f32_16x16x32_bf16 v[172:175], v[108:111], v[128:131], v[172:175]
    ds_read_b64 v[94:95], v211 offset:8840
    v_mfma_f32_16x16x32_bf16 v[180:183], v[108:111], v[132:135], v[180:183]
    ds_read_b128 v[56:59], v199 offset:1168
    v_mfma_f32_16x16x32_bf16 v[176:179], v[104:107], v[132:135], v[176:179]
    ds_read_b128 v[60:63], v199 offset:5520
    v_mfma_f32_16x16x32_bf16 v[184:187], v[104:107], v[136:139], v[184:187]
    ds_read_b128 v[64:67], v199 offset:2192
    v_mfma_f32_16x16x32_bf16 v[188:191], v[108:111], v[136:139], v[188:191]
    ds_read_b128 v[68:71], v199 offset:6544
    v_mfma_f32_16x16x32_bf16 v[176:179], v[112:115], v[128:131], v[176:179]
    ds_read_b128 v[72:75], v199 offset:3216
    v_mfma_f32_16x16x32_bf16 v[180:183], v[116:119], v[128:131], v[180:183]
    ds_read_b128 v[76:79], v199 offset:7568
    v_mfma_f32_16x16x32_bf16 v[188:191], v[116:119], v[132:135], v[188:191]
    v_mfma_f32_16x16x32_bf16 v[184:187], v[112:115], v[132:135], v[184:187]
    v_mfma_f32_16x16x32_bf16 v[184:187], v[120:123], v[128:131], v[184:187]
    v_mfma_f32_16x16x32_bf16 v[188:191], v[124:127], v[128:131], v[188:191]
    s_waitcnt lgkmcnt(0)
    s_nop 0
    v_mfma_f32_16x16x32_bf16 v[160:163], v[48:51], v[80:83], v[160:163]
    ds_read_b64 v[128:129], v211 offset:12352
    v_mfma_f32_16x16x32_bf16 v[164:167], v[52:55], v[80:83], v[164:167]
    ds_read_b64 v[130:131], v207 offset:12360
    v_mfma_f32_16x16x32_bf16 v[172:175], v[52:55], v[84:87], v[172:175]
    ds_read_b128 v[96:99], v199 offset:208
    v_mfma_f32_16x16x32_bf16 v[168:171], v[48:51], v[84:87], v[168:171]
    ds_read_b128 v[100:103], v199 offset:4560
    v_mfma_f32_16x16x32_bf16 v[176:179], v[48:51], v[88:91], v[176:179]
    ds_read_b64 v[132:133], v211 offset:11200
    v_mfma_f32_16x16x32_bf16 v[180:183], v[52:55], v[88:91], v[180:183]
    ds_read_b64 v[134:135], v207 offset:11208
    v_mfma_f32_16x16x32_bf16 v[188:191], v[52:55], v[92:95], v[188:191]
    ds_read_b64 v[136:137], v211 offset:10048
    v_mfma_f32_16x16x32_bf16 v[184:187], v[48:51], v[92:95], v[184:187]
    ds_read_b64 v[138:139], v207 offset:10056
    v_mfma_f32_16x16x32_bf16 v[168:171], v[56:59], v[80:83], v[168:171]
    ds_read_b64 v[140:141], v211 offset:8896
    v_mfma_f32_16x16x32_bf16 v[172:175], v[60:63], v[80:83], v[172:175]
    ds_read_b64 v[142:143], v207 offset:8904
    v_mfma_f32_16x16x32_bf16 v[180:183], v[60:63], v[84:87], v[180:183]
    ds_read_b128 v[104:107], v199 offset:1232
    v_mfma_f32_16x16x32_bf16 v[176:179], v[56:59], v[84:87], v[176:179]
    ds_read_b128 v[108:111], v199 offset:5584
    v_mfma_f32_16x16x32_bf16 v[184:187], v[56:59], v[88:91], v[184:187]
    ds_read_b128 v[112:115], v199 offset:2256
    v_mfma_f32_16x16x32_bf16 v[188:191], v[60:63], v[88:91], v[188:191]
    ds_read_b128 v[116:119], v199 offset:6608
    v_mfma_f32_16x16x32_bf16 v[176:179], v[64:67], v[80:83], v[176:179]
    ds_read_b128 v[120:123], v199 offset:3280
    v_mfma_f32_16x16x32_bf16 v[180:183], v[68:71], v[80:83], v[180:183]
    ds_read_b128 v[124:127], v199 offset:7632
    v_mfma_f32_16x16x32_bf16 v[188:191], v[68:71], v[84:87], v[188:191]
    v_mfma_f32_16x16x32_bf16 v[184:187], v[64:67], v[84:87], v[184:187]
    v_mfma_f32_16x16x32_bf16 v[184:187], v[72:75], v[80:83], v[184:187]
    v_mfma_f32_16x16x32_bf16 v[188:191], v[76:79], v[80:83], v[188:191]
    s_waitcnt lgkmcnt(0)
    s_nop 0
    s_cmp_eq_u32 s64, 3
    s_cbranch_scc1 L_conv_last
    v_mfma_f32_16x16x32_bf16 v[160:163], v[96:99], v[128:131], v[160:163]
    ds_read_b64 v[80:81], v211 offset:12448
    v_mfma_f32_16x16x32_bf16 v[164:167], v[100:103], v[128:131], v[164:167]
    ds_read_b64 v[82:83], v211 offset:12456
    v_mfma_f32_16x16x32_bf16 v[172:175], v[100:103], v[132:135], v[172:175]
    ds_read_b128 v[48:51], v199 offset:272
    v_mfma_f32_16x16x32_bf16 v[168:171], v[96:99], v[132:135], v[168:171]
    ds_read_b128 v[52:55], v199 offset:4624
    v_mfma_f32_16x16x32_bf16 v[176:179], v[96:99], v[136:139], v[176:179]
    ds_read_b64 v[84:85], v211 offset:11296
    v_mfma_f32_16x16x32_bf16 v[180:183], v[100:103], v[136:139], v[180:183]
    ds_read_b64 v[86:87], v211 offset:11304
    v_mfma_f32_16x16x32_bf16 v[188:191], v[100:103], v[140:143], v[188:191]
    ds_read_b64 v[88:89], v211 offset:10144
    v_mfma_f32_16x16x32_bf16 v[184:187], v[96:99], v[140:143], v[184:187]
    ds_read_b64 v[90:91], v211 offset:10152
    v_mfma_f32_16x16x32_bf16 v[168:171], v[104:107], v[128:131], v[168:171]
    ds_read_b64 v[92:93], v211 offset:8992
    v_mfma_f32_16x16x32_bf16 v[172:175], v[108:111], v[128:131], v[172:175]
    ds_read_b64 v[94:95], v211 offset:9000
    v_mfma_f32_16x16x32_bf16 v[180:183], v[108:111], v[132:135], v[180:183]
    ds_read_b128 v[56:59], v199 offset:1296
    v_mfma_f32_16x16x32_bf16 v[176:179], v[104:107], v[132:135], v[176:179]
    ds_read_b128 v[60:63], v199 offset:5648
    v_mfma_f32_16x16x32_bf16 v[184:187], v[104:107], v[136:139], v[184:187]
    ds_read_b128 v[64:67], v199 offset:2320
    v_mfma_f32_16x16x32_bf16 v[188:191], v[108:111], v[136:139], v[188:191]
    ds_read_b128 v[68:71], v199 offset:6672
    v_mfma_f32_16x16x32_bf16 v[176:179], v[112:115], v[128:131], v[176:179]
    ds_read_b128 v[72:75], v199 offset:3344
    v_mfma_f32_16x16x32_bf16 v[180:183], v[116:119], v[128:131], v[180:183]
    ds_read_b128 v[76:79], v199 offset:7696
    v_mfma_f32_16x16x32_bf16 v[188:191], v[116:119], v[132:135], v[188:191]
    v_mfma_f32_16x16x32_bf16 v[184:187], v[112:115], v[132:135], v[184:187]
    v_mfma_f32_16x16x32_bf16 v[184:187], v[120:123], v[128:131], v[184:187]
    v_mfma_f32_16x16x32_bf16 v[188:191], v[124:127], v[128:131], v[188:191]
    v_add_u32 v199, 256, v199
    v_add_u32 v211, 288, v211
    v_add_u32 v207, 288, v207
    s_add_u32 s64, s64, 1
    s_branch L_conv_loop
L_conv_last:
    s_waitcnt vmcnt(0)
    v_mfma_f32_16x16x32_bf16 v[160:163], v[96:99], v[128:131], v[160:163]
    v_mfma_f32_16x16x32_bf16 v[164:167], v[100:103], v[128:131], v[164:167]
    v_mfma_f32_16x16x32_bf16 v[172:175], v[100:103], v[132:135], v[172:175]
    v_mfma_f32_16x16x32_bf16 v[168:171], v[96:99], v[132:135], v[168:171]
    v_mfma_f32_16x16x32_bf16 v[176:179], v[96:99], v[136:139], v[176:179]
    v_mfma_f32_16x16x32_bf16 v[180:183], v[100:103], v[136:139], v[180:183]
    v_mfma_f32_16x16x32_bf16 v[188:191], v[100:103], v[140:143], v[188:191]
    v_mfma_f32_16x16x32_bf16 v[184:187], v[96:99], v[140:143], v[184:187]
    v_mfma_f32_16x16x32_bf16 v[168:171], v[104:107], v[128:131], v[168:171]
    v_mfma_f32_16x16x32_bf16 v[172:175], v[108:111], v[128:131], v[172:175]
    v_mfma_f32_16x16x32_bf16 v[180:183], v[108:111], v[132:135], v[180:183]
    v_mfma_f32_16x16x32_bf16 v[176:179], v[104:107], v[132:135], v[176:179]
    s_barrier
    v_mfma_f32_16x16x32_bf16 v[184:187], v[104:107], v[136:139], v[184:187]
    v_mfma_f32_16x16x32_bf16 v[188:191], v[108:111], v[136:139], v[188:191]
    v_mfma_f32_16x16x32_bf16 v[176:179], v[112:115], v[128:131], v[176:179]
    v_mfma_f32_16x16x32_bf16 v[180:183], v[116:119], v[128:131], v[180:183]
    v_mfma_f32_16x16x32_bf16 v[188:191], v[116:119], v[132:135], v[188:191]
    v_mfma_f32_16x16x32_bf16 v[184:187], v[112:115], v[132:135], v[184:187]
    v_mfma_f32_16x16x32_bf16 v[184:187], v[120:123], v[128:131], v[184:187]
    v_mfma_f32_16x16x32_bf16 v[188:191], v[124:127], v[128:131], v[188:191]
    s_setprio 0
    s_add_u32 m0, s77, 96256
    s_nop 0
    buffer_load_dwordx4 v196, s[8:11], s74 offen offset:0 sc1 lds
    buffer_load_dwordx4 v196, s[8:11], s74 offen offset:1024 sc1 lds
    buffer_load_dwordx4 v196, s[8:11], s74 offen offset:2048 sc1 lds
    buffer_load_dwordx4 v196, s[8:11], s74 offen offset:3072 sc1 lds
    s_add_u32 m0, s77, 79872
    s_nop 0
    buffer_load_dwordx4 v200, s[12:15], s75 offen offset:0 lds
    buffer_load_dwordx4 v201, s[12:15], s75 offen offset:1024 lds
    buffer_load_dwordx4 v202, s[12:15], s75 offen offset:2048 lds
    buffer_load_dwordx4 v203, s[12:15], s75 offen offset:3072 lds
    s_lshl_b32 s35, s4, 9
    s_lshl_b32 s62, s76, 5
    s_add_u32 s35, s35, s62
    s_add_u32 s35, s35, 32768
    buffer_load_dwordx2 v[208:209], v210, s[28:31], s35 offen sc1
    s_lshr_b32 s60, 0x1010101, s84
    s_bfe_u32 s61, s60, 0x20003
    s_add_u32 s60, s60, s72
    s_and_b32 s60, s60, 7
    s_mul_i32 s74, s60, 3
    s_add_u32 s74, s74, s61
    s_lshl_b32 s74, s74, 14
    s_add_u32 s74, s74, s79
    s_mul_i32 s60, s60, 7
    s_add_u32 s60, s60, s61
    s_add_u32 s60, s60, s34
    s_lshl_b32 s75, s60, 16
    s_barrier
    s_add_u32 m0, s77, 129024
    s_nop 0
    buffer_load_dwordx4 v196, s[8:11], s74 offen offset:0 sc1 lds
    buffer_load_dwordx4 v196, s[8:11], s74 offen offset:1024 sc1 lds
    buffer_load_dwordx4 v196, s[8:11], s74 offen offset:2048 sc1 lds
    buffer_load_dwordx4 v196, s[8:11], s74 offen offset:3072 sc1 lds
    s_add_u32 m0, s77, 112640
    s_nop 0
    buffer_load_dwordx4 v200, s[12:15], s75 offen offset:0 lds
    buffer_load_dwordx4 v201, s[12:15], s75 offen offset:1024 lds
    buffer_load_dwordx4 v202, s[12:15], s75 offen offset:2048 lds
    buffer_load_dwordx4 v203, s[12:15], s75 offen offset:3072 lds
    s_lshr_b32 s60, 0x2020202, s84
    s_bfe_u32 s61, s60, 0x20003
    s_add_u32 s60, s60, s72
    s_and_b32 s60, s60, 7
    s_mul_i32 s74, s60, 3
    s_add_u32 s74, s74, s61
    s_lshl_b32 s74, s74, 14
    s_add_u32 s74, s74, s79
    s_mul_i32 s60, s60, 7
    s_add_u32 s60, s60, s61
    s_add_u32 s60, s60, s34
    s_lshl_b32 s75, s60, 16
    s_waitcnt vmcnt(9)
    s_barrier
    s_add_u32 m0, s77, 16384
    s_nop 0
    buffer_load_dwordx4 v196, s[8:11], s74 offen offset:0 sc1 lds
    buffer_load_dwordx4 v196, s[8:11], s74 offen offset:1024 sc1 lds
    buffer_load_dwordx4 v196, s[8:11], s74 offen offset:2048 sc1 lds
    buffer_load_dwordx4 v196, s[8:11], s74 offen offset:3072 sc1 lds
    s_add_u32 m0, s77, 0
    s_nop 0
    buffer_load_dwordx4 v200, s[12:15], s75 offen offset:0 lds
    buffer_load_dwordx4 v201, s[12:15], s75 offen offset:1024 lds
    buffer_load_dwordx4 v202, s[12:15], s75 offen offset:2048 lds
    buffer_load_dwordx4 v203, s[12:15], s75 offen offset:3072 lds
    s_waitcnt vmcnt(16)
    v_cmp_ne_u64 vcc, s[94:95], v[208:209]
    s_cbranch_vccz L_rpok_10
    s_mov_b32 s62, 200000
L_rp_9:
    s_sleep 2
    buffer_load_dwordx2 v[208:209], v210, s[28:31], s35 offen sc1
    s_waitcnt vmcnt(0)
    v_cmp_ne_u64 vcc, s[94:95], v[208:209]
    s_cbranch_vccz L_rpok_10
    s_sub_u32 s62, s62, 1
    s_cmp_lg_u32 s62, 0
    s_cbranch_scc1 L_rp_9
L_rpok_10:
    s_lshr_b32 s60, 0x5030303, s84
    s_bfe_u32 s61, s60, 0x20003
    s_add_u32 s60, s60, s72
    s_and_b32 s60, s60, 7
    s_mul_i32 s74, s60, 3
    s_add_u32 s74, s74, s61
    s_lshl_b32 s74, s74, 14
    s_add_u32 s74, s74, s79
    s_mul_i32 s60, s60, 7
    s_add_u32 s60, s60, s61
    s_add_u32 s60, s60, s34
    s_lshl_b32 s75, s60, 16
    s_waitcnt vmcnt(8)
    s_barrier
    s_add_u32 m0, s77, 49152
    s_nop 0
    buffer_load_dwordx4 v196, s[8:11], s74 offen offset:0 sc1 lds
    buffer_load_dwordx4 v196, s[8:11], s74 offen offset:1024 sc1 lds
    buffer_load_dwordx4 v196, s[8:11], s74 offen offset:2048 sc1 lds
    buffer_load_dwordx4 v196, s[8:11], s74 offen offset:3072 sc1 lds
    s_add_u32 m0, s77, 32768
    s_nop 0
    buffer_load_dwordx4 v200, s[12:15], s75 offen offset:0 lds
    buffer_load_dwordx4 v201, s[12:15], s75 offen offset:1024 lds
    buffer_load_dwordx4 v202, s[12:15], s75 offen offset:2048 lds
    buffer_load_dwordx4 v203, s[12:15], s75 offen offset:3072 lds
    s_lshl_b32 s35, s4, 9
    s_lshl_b32 s62, s76, 5
    s_add_u32 s35, s35, s62
    s_add_u32 s35, s35, 16384
    buffer_load_dwordx2 v[208:209], v210, s[28:31], s35 offen sc1
    s_lshr_b32 s60, 0x3040406, s84
    s_bfe_u32 s61, s60, 0x20003
    s_add_u32 s60, s60, s72
    s_and_b32 s60, s60, 7
    s_mul_i32 s74, s60, 3
    s_add_u32 s74, s74, s61
    s_lshl_b32 s74, s74, 14
    s_add_u32 s74, s74, s79
    s_mul_i32 s60, s60, 7
    s_add_u32 s60, s60, s61
    s_add_u32 s60, s60, s34
    s_lshl_b32 s75, s60, 16
    s_waitcnt vmcnt(9)
    s_barrier
    s_add_u32 m0, s77, 96256
    s_nop 0
    buffer_load_dwordx4 v196, s[8:11], s74 offen offset:0 sc1 lds
    buffer_load_dwordx4 v196, s[8:11], s74 offen offset:1024 sc1 lds
    buffer_load_dwordx4 v196, s[8:11], s74 offen offset:2048 sc1 lds
    buffer_load_dwordx4 v196, s[8:11], s74 offen offset:3072 sc1 lds
    s_add_u32 m0, s77, 79872
    s_nop 0
    buffer_load_dwordx4 v200, s[12:15], s75 offen offset:0 lds
    buffer_load_dwordx4 v201, s[12:15], s75 offen offset:1024 lds
    buffer_load_dwordx4 v202, s[12:15], s75 offen offset:2048 lds
    buffer_load_dwordx4 v203, s[12:15], s75 offen offset:3072 lds
    v_cvt_pk_bf16_f32 v144, v160, v164
    v_cvt_pk_bf16_f32 v145, v161, v165
    v_cvt_pk_bf16_f32 v146, v162, v166
    v_cvt_pk_bf16_f32 v147, v163, v167
    buffer_store_dwordx4 v[144:147], v206, s[16:19], s69 offen offset:0 sc1
    v_cvt_pk_bf16_f32 v148, v168, v172
    v_cvt_pk_bf16_f32 v149, v169, v173
    v_cvt_pk_bf16_f32 v150, v170, v174
    v_cvt_pk_bf16_f32 v151, v171, v175
    buffer_store_dwordx4 v[148:151], v206, s[16:19], s69 offen offset:1024 sc1
    s_lshr_b32 s60, 0x4050704, s84
    s_bfe_u32 s61, s60, 0x20003
    s_add_u32 s60, s60, s72
    s_and_b32 s60, s60, 7
    s_mul_i32 s74, s60, 3
    s_add_u32 s74, s74, s61
    s_lshl_b32 s74, s74, 14
    s_add_u32 s74, s74, s79
    s_mul_i32 s60, s60, 7
    s_add_u32 s60, s60, s61
    s_add_u32 s60, s60, s34
    s_lshl_b32 s75, s60, 16
    s_waitcnt vmcnt(11)
    s_barrier
    s_add_u32 m0, s77, 129024
    s_nop 0
    buffer_load_dwordx4 v196, s[8:11], s74 offen offset:0 sc1 lds
    buffer_load_dwordx4 v196, s[8:11], s74 offen offset:1024 sc1 lds
    buffer_load_dwordx4 v196, s[8:11], s74 offen offset:2048 sc1 lds
    buffer_load_dwordx4 v196, s[8:11], s74 offen offset:3072 sc1 lds
    s_add_u32 m0, s77, 112640
    s_nop 0
    buffer_load_dwordx4 v200, s[12:15], s75 offen offset:0 lds
    buffer_load_dwordx4 v201, s[12:15], s75 offen offset:1024 lds
    buffer_load_dwordx4 v202, s[12:15], s75 offen offset:2048 lds
    buffer_load_dwordx4 v203, s[12:15], s75 offen offset:3072 lds
    v_cvt_pk_bf16_f32 v152, v176, v180
    v_cvt_pk_bf16_f32 v153, v177, v181
    v_cvt_pk_bf16_f32 v154, v178, v182
    v_cvt_pk_bf16_f32 v155, v179, v183
    buffer_store_dwordx4 v[152:155], v206, s[16:19], s69 offen offset:2048 sc1
    v_cvt_pk_bf16_f32 v156, v184, v188
    v_cvt_pk_bf16_f32 v157, v185, v189
    v_cvt_pk_bf16_f32 v158, v186, v190
    v_cvt_pk_bf16_f32 v159, v187, v191
    buffer_store_dwordx4 v[156:159], v206, s[16:19], s69 offen offset:3072 sc1
    s_waitcnt vmcnt(20)
    v_cmp_ne_u64 vcc, s[94:95], v[208:209]
    s_cbranch_vccz L_rpok_12
    s_mov_b32 s62, 200000
L_rp_11:
    s_sleep 2
    buffer_load_dwordx2 v[208:209], v210, s[28:31], s35 offen sc1
    s_waitcnt vmcnt(0)
    v_cmp_ne_u64 vcc, s[94:95], v[208:209]
    s_cbranch_vccz L_rpok_12
    s_sub_u32 s62, s62, 1
    s_cmp_lg_u32 s62, 0
    s_cbranch_scc1 L_rp_11
L_rpok_12:
    s_lshr_b32 s60, 0x6090505, s84
    s_bfe_u32 s61, s60, 0x20003
    s_add_u32 s60, s60, s72
    s_and_b32 s60, s60, 7
    s_mul_i32 s74, s60, 3
    s_add_u32 s74, s74, s61
    s_lshl_b32 s74, s74, 14
    s_add_u32 s74, s74, s79
    s_mul_i32 s60, s60, 7
    s_add_u32 s60, s60, s61
    s_add_u32 s60, s60, s34
    s_lshl_b32 s75, s60, 16
    s_waitcnt vmcnt(12)
    s_barrier
    s_add_u32 m0, s77, 16384
    s_nop 0
    buffer_load_dwordx4 v196, s[8:11], s74 offen offset:0 sc1 lds
    buffer_load_dwordx4 v196, s[8:11], s74 offen offset:1024 sc1 lds
    buffer_load_dwordx4 v196, s[8:11], s74 offen offset:2048 sc1 lds
    buffer_load_dwordx4 v196, s[8:11], s74 offen offset:3072 sc1 lds
    s_add_u32 m0, s77, 0
    s_nop 0
    buffer_load_dwordx4 v200, s[12:15], s75 offen offset:0 lds
    buffer_load_dwordx4 v201, s[12:15], s75 offen offset:1024 lds
    buffer_load_dwordx4 v202, s[12:15], s75 offen offset:2048 lds
    buffer_load_dwordx4 v203, s[12:15], s75 offen offset:3072 lds
    s_lshr_b32 s60, 0xa060607, s84
    s_bfe_u32 s61, s60, 0x20003
    s_add_u32 s60, s60, s72
    s_and_b32 s60, s60, 7
    s_mul_i32 s74, s60, 3
    s_add_u32 s74, s74, s61
    s_lshl_b32 s74, s74, 14
    s_add_u32 s74, s74, s79
    s_mul_i32 s60, s60, 7
    s_add_u32 s60, s60, s61
    s_add_u32 s60, s60, s34
    s_lshl_b32 s75, s60, 16
    s_waitcnt vmcnt(10)
    s_barrier
    s_add_u32 m0, s77, 49152
    s_nop 0
    buffer_load_dwordx4 v196, s[8:11], s74 offen offset:0 sc1 lds
    buffer_load_dwordx4 v196, s[8:11], s74 offen offset:1024 sc1 lds
    buffer_load_dwordx4 v196, s[8:11], s74 offen offset:2048 sc1 lds
    buffer_load_dwordx4 v196, s[8:11], s74 offen offset:3072 sc1 lds
    s_add_u32 m0, s77, 32768
    s_nop 0
    buffer_load_dwordx4 v200, s[12:15], s75 offen offset:0 lds
    buffer_load_dwordx4 v201, s[12:15], s75 offen offset:1024 lds
    buffer_load_dwordx4 v202, s[12:15], s75 offen offset:2048 lds
    buffer_load_dwordx4 v203, s[12:15], s75 offen offset:3072 lds
    v_lshrrev_b32 v4, 3, v1
    v_and_b32 v9, 7, v1
    v_lshlrev_b32 v9, 4, v9
    v_lshl_add_u32 v20, v4, 12, v9
    v_add_u32 v21, 31744, v20
    v_add_u32 v22, 63488, v20
    v_add_u32 v23, 95232, v20
    v_lshlrev_b32 v28, 3, v1
    s_lshr_b32 s60, 0x707090b, s84
    s_bfe_u32 s61, s60, 0x20003
    s_add_u32 s60, s60, s72
    s_and_b32 s60, s60, 7
    s_mul_i32 s74, s60, 3
    s_add_u32 s74, s74, s61
    s_lshl_b32 s74, s74, 14
    s_add_u32 s74, s74, s79
    s_mul_i32 s60, s60, 7
    s_add_u32 s60, s60, s61
    s_add_u32 s60, s60, s34
    s_lshl_b32 s75, s60, 16
    s_waitcnt vmcnt(8)
    s_barrier
    s_add_u32 m0, s77, 96256
    s_nop 0
    buffer_load_dwordx4 v196, s[8:11], s74 offen offset:0 sc1 lds
    buffer_load_dwordx4 v196, s[8:11], s74 offen offset:1024 sc1 lds
    buffer_load_dwordx4 v196, s[8:11], s74 offen offset:2048 sc1 lds
    buffer_load_dwordx4 v196, s[8:11], s74 offen offset:3072 sc1 lds
    s_add_u32 m0, s77, 79872
    s_nop 0
    buffer_load_dwordx4 v200, s[12:15], s75 offen offset:0 lds
    buffer_load_dwordx4 v201, s[12:15], s75 offen offset:1024 lds
    buffer_load_dwordx4 v202, s[12:15], s75 offen offset:2048 lds
    buffer_load_dwordx4 v203, s[12:15], s75 offen offset:3072 lds
    s_lshl_b32 s62, s68, 3
    s_add_u32 s62, s62, 24576
    v_mov_b32 v248, s94
    v_mov_b32 v249, s95
    s_mov_b64 exec, 1
    buffer_store_dwordx2 v[248:249], off, s[28:31], s62 sc1
    s_mov_b64 exec, -1
    s_lshr_b32 s65, s6, 6
    s_add_u32 s65, s65, s73
    s_lshl_b32 s69, s65, 17
    s_lshl_b32 s62, s4, 8
    s_add_u32 s69, s69, s62
    s_lshl_b32 s62, s32, 7
    s_add_u32 s69, s69, s62
    s_mul_i32 s70, s73, 79872
    s_lshl_b32 s62, s32, 15
    s_add_u32 s64, s70, s62
    s_add_u32 s64, s64, 8192
    s_lshl_b32 s62, s32, 12
    s_add_u32 s70, s70, s62
    s_add_u32 s70, s70, 65536
    s_add_u32 s20, s58, 0x1a00000
    s_addc_u32 s21, s59, 0
    s_mov_b32 s22, 0x400000
    s_mov_b32 s23, 0x20000
    s_lshr_b32 s60, 0x90a0c09, s84
    s_bfe_u32 s61, s60, 0x20003
    s_add_u32 s60, s60, s72
    s_and_b32 s60, s60, 7
    s_mul_i32 s74, s60, 3
    s_add_u32 s74, s74, s61
    s_lshl_b32 s74, s74, 14
    s_add_u32 s74, s74, s79
    s_mul_i32 s60, s60, 7
    s_add_u32 s60, s60, s61
    s_add_u32 s60, s60, s34
    s_lshl_b32 s75, s60, 16
    s_waitcnt vmcnt(9)
    s_barrier
    s_add_u32 m0, s77, 129024
    s_nop 0
    buffer_load_dwordx4 v196, s[8:11], s74 offen offset:0 sc1 lds
    buffer_load_dwordx4 v196, s[8:11], s74 offen offset:1024 sc1 lds
    buffer_load_dwordx4 v196, s[8:11], s74 offen offset:2048 sc1 lds
    buffer_load_dwordx4 v196, s[8:11], s74 offen offset:3072 sc1 lds
    s_add_u32 m0, s77, 112640
    s_nop 0
    buffer_load_dwordx4 v200, s[12:15], s75 offen offset:0 lds
    buffer_load_dwordx4 v201, s[12:15], s75 offen offset:1024 lds
    buffer_load_dwordx4 v202, s[12:15], s75 offen offset:2048 lds
    buffer_load_dwordx4 v203, s[12:15], s75 offen offset:3072 lds
    s_lshr_b32 s60, 0xb0d0a0a, s84
    s_bfe_u32 s61, s60, 0x20003
    s_add_u32 s60, s60, s72
    s_and_b32 s60, s60, 7
    s_mul_i32 s74, s60, 3
    s_add_u32 s74, s74, s61
    s_lshl_b32 s74, s74, 14
    s_add_u32 s74, s74, s79
    s_mul_i32 s60, s60, 7
    s_add_u32 s60, s60, s61
    s_add_u32 s60, s60, s34
    s_lshl_b32 s75, s60, 16
    s_waitcnt vmcnt(9)
    s_barrier
    s_add_u32 m0, s77, 16384
    s_nop 0
    buffer_load_dwordx4 v196, s[8:11], s74 offen offset:0 sc1 lds
    buffer_load_dwordx4 v196, s[8:11], s74 offen offset:1024 sc1 lds
    buffer_load_dwordx4 v196, s[8:11], s74 offen offset:2048 sc1 lds
    buffer_load_dwordx4 v196, s[8:11], s74 offen offset:3072 sc1 lds
    s_add_u32 m0, s77, 0
    s_nop 0
    buffer_load_dwordx4 v200, s[12:15], s75 offen offset:0 lds
    buffer_load_dwordx4 v201, s[12:15], s75 offen offset:1024 lds
    buffer_load_dwordx4 v202, s[12:15], s75 offen offset:2048 lds
    buffer_load_dwordx4 v203, s[12:15], s75 offen offset:3072 lds
    s_lshr_b32 s60, 0xe0b0b0c, s84
    s_bfe_u32 s61, s60, 0x20003
    s_add_u32 s60, s60, s72
    s_and_b32 s60, s60, 7
    s_mul_i32 s74, s60, 3
    s_add_u32 s74, s74, s61
    s_lshl_b32 s74, s74, 14
    s_add_u32 s74, s74, s79
    s_mul_i32 s60, s60, 7
    s_add_u32 s60, s60, s61
    s_add_u32 s60, s60, s34
    s_lshl_b32 s75, s60, 16
    s_waitcnt vmcnt(8)
    s_barrier
    s_add_u32 m0, s77, 49152
    s_nop 0
    buffer_load_dwordx4 v196, s[8:11], s74 offen offset:0 sc1 lds
    buffer_load_dwordx4 v196, s[8:11], s74 offen offset:1024 sc1 lds
    buffer_load_dwordx4 v196, s[8:11], s74 offen offset:2048 sc1 lds
    buffer_load_dwordx4 v196, s[8:11], s74 offen offset:3072 sc1 lds
    s_add_u32 m0, s77, 32768
    s_nop 0
    buffer_load_dwordx4 v200, s[12:15], s75 offen offset:0 lds
    buffer_load_dwordx4 v201, s[12:15], s75 offen offset:1024 lds
    buffer_load_dwordx4 v202, s[12:15], s75 offen offset:2048 lds
    buffer_load_dwordx4 v203, s[12:15], s75 offen offset:3072 lds
    s_lshr_b32 s60, 0xc0c0d0f, s84
    s_bfe_u32 s61, s60, 0x20003
    s_add_u32 s60, s60, s72
    s_and_b32 s60, s60, 7
    s_mul_i32 s74, s60, 3
    s_add_u32 s74, s74, s61
    s_lshl_b32 s74, s74, 14
    s_add_u32 s74, s74, s79
    s_mul_i32 s60, s60, 7
    s_add_u32 s60, s60, s61
    s_add_u32 s60, s60, s34
    s_lshl_b32 s75, s60, 16
    s_waitcnt vmcnt(8)
    s_barrier
    s_add_u32 m0, s77, 96256
    s_nop 0
    buffer_load_dwordx4 v196, s[8:11], s74 offen offset:0 sc1 lds
    buffer_load_dwordx4 v196, s[8:11], s74 offen offset:1024 sc1 lds
    buffer_load_dwordx4 v196, s[8:11], s74 offen offset:2048 sc1 lds
    buffer_load_dwordx4 v196, s[8:11], s74 offen offset:3072 sc1 lds
    s_add_u32 m0, s77, 79872
    s_nop 0
    buffer_load_dwordx4 v200, s[12:15], s75 offen offset:0 lds
    buffer_load_dwordx4 v201, s[12:15], s75 offen offset:1024 lds
    buffer_load_dwordx4 v202, s[12:15], s75 offen offset:2048 lds
    buffer_load_dwordx4 v203, s[12:15], s75 offen offset:3072 lds
    s_lshr_b32 s60, 0xd0e110d, s84
    s_bfe_u32 s61, s60, 0x20003
    s_add_u32 s60, s60, s72
    s_and_b32 s60, s60, 7
    s_mul_i32 s74, s60, 3
    s_add_u32 s74, s74, s61
    s_lshl_b32 s74, s74, 14
    s_add_u32 s74, s74, s79
    s_mul_i32 s60, s60, 7
    s_add_u32 s60, s60, s61
    s_add_u32 s60, s60, s34
    s_lshl_b32 s75, s60, 16
    s_waitcnt vmcnt(8)
    s_barrier
    s_add_u32 m0, s77, 129024
    s_nop 0
    buffer_load_dwordx4 v196, s[8:11], s74 offen offset:0 sc1 lds
    buffer_load_dwordx4 v196, s[8:11], s74 offen offset:1024 sc1 lds
    buffer_load_dwordx4 v196, s[8:11], s74 offen offset:2048 sc1 lds
    buffer_load_dwordx4 v196, s[8:11], s74 offen offset:3072 sc1 lds
    s_add_u32 m0, s77, 112640
    s_nop 0
    buffer_load_dwordx4 v200, s[12:15], s75 offen offset:0 lds
    buffer_load_dwordx4 v201, s[12:15], s75 offen offset:1024 lds
    buffer_load_dwordx4 v202, s[12:15], s75 offen offset:2048 lds
    buffer_load_dwordx4 v203, s[12:15], s75 offen offset:3072 lds
    s_lshr_b32 s60, 0xf120e0e, s84
    s_bfe_u32 s61, s60, 0x20003
    s_add_u32 s60, s60, s72
    s_and_b32 s60, s60, 7
    s_mul_i32 s74, s60, 3
    s_add_u32 s74, s74, s61
    s_lshl_b32 s74, s74, 14
    s_add_u32 s74, s74, s79
    s_mul_i32 s60, s60, 7
    s_add_u32 s60, s60, s61
    s_add_u32 s60, s60, s34
    s_lshl_b32 s75, s60, 16
    s_waitcnt vmcnt(8)
    s_barrier
    s_add_u32 m0, s77, 16384
    s_nop 0
    buffer_load_dwordx4 v196, s[8:11], s74 offen offset:0 sc1 lds
    buffer_load_dwordx4 v196, s[8:11], s74 offen offset:1024 sc1 lds
    buffer_load_dwordx4 v196, s[8:11], s74 offen offset:2048 sc1 lds
    buffer_load_dwordx4 v196, s[8:11], s74 offen offset:3072 sc1 lds
    s_add_u32 m0, s77, 0
    s_nop 0
    buffer_load_dwordx4 v200, s[12:15], s75 offen offset:0 lds
    buffer_load_dwordx4 v201, s[12:15], s75 offen offset:1024 lds
    buffer_load_dwordx4 v202, s[12:15], s75 offen offset:2048 lds
    buffer_load_dwordx4 v203, s[12:15], s75 offen offset:3072 lds
    s_lshr_b32 s60, 0x130f0f11, s84
    s_bfe_u32 s61, s60, 0x20003
    s_add_u32 s60, s60, s72
    s_and_b32 s60, s60, 7
    s_mul_i32 s74, s60, 3
    s_add_u32 s74, s74, s61
    s_lshl_b32 s74, s74, 14
    s_add_u32 s74, s74, s79
    s_mul_i32 s60, s60, 7
    s_add_u32 s60, s60, s61
    s_add_u32 s60, s60, s34
    s_lshl_b32 s75, s60, 16
    s_waitcnt vmcnt(8)
    s_barrier
    s_add_u32 m0, s77, 49152
    s_nop 0
    buffer_load_dwordx4 v196, s[8:11], s74 offen offset:0 sc1 lds
    buffer_load_dwordx4 v196, s[8:11], s74 offen offset:1024 sc1 lds
    buffer_load_dwordx4 v196, s[8:11], s74 offen offset:2048 sc1 lds
    buffer_load_dwordx4 v196, s[8:11], s74 offen offset:3072 sc1 lds
    s_add_u32 m0, s77, 32768
    s_nop 0
    buffer_load_dwordx4 v200, s[12:15], s75 offen offset:0 lds
    buffer_load_dwordx4 v201, s[12:15], s75 offen offset:1024 lds
    buffer_load_dwordx4 v202, s[12:15], s75 offen offset:2048 lds
    buffer_load_dwordx4 v203, s[12:15], s75 offen offset:3072 lds
    s_lshr_b32 s60, 0x11111214, s84
    s_bfe_u32 s61, s60, 0x20003
    s_add_u32 s60, s60, s72
    s_and_b32 s60, s60, 7
    s_mul_i32 s74, s60, 3
    s_add_u32 s74, s74, s61
    s_lshl_b32 s74, s74, 14
    s_add_u32 s74, s74, s79
    s_mul_i32 s60, s60, 7
    s_add_u32 s60, s60, s61
    s_add_u32 s60, s60, s34
    s_lshl_b32 s75, s60, 16
    s_waitcnt vmcnt(8)
    s_barrier
    s_add_u32 m0, s77, 96256
    s_nop 0
    buffer_load_dwordx4 v196, s[8:11], s74 offen offset:0 sc1 lds
    buffer_load_dwordx4 v196, s[8:11], s74 offen offset:1024 sc1 lds
    buffer_load_dwordx4 v196, s[8:11], s74 offen offset:2048 sc1 lds
    buffer_load_dwordx4 v196, s[8:11], s74 offen offset:3072 sc1 lds
    s_add_u32 m0, s77, 79872
    s_nop 0
    buffer_load_dwordx4 v200, s[12:15], s75 offen offset:0 lds
    buffer_load_dwordx4 v201, s[12:15], s75 offen offset:1024 lds
    buffer_load_dwordx4 v202, s[12:15], s75 offen offset:2048 lds
    buffer_load_dwordx4 v203, s[12:15], s75 offen offset:3072 lds
    s_lshr_b32 s60, 0x12131512, s84
    s_bfe_u32 s61, s60, 0x20003
    s_add_u32 s60, s60, s72
    s_and_b32 s60, s60, 7
    s_mul_i32 s74, s60, 3
    s_add_u32 s74, s74, s61
    s_lshl_b32 s74, s74, 14
    s_add_u32 s74, s74, s79
    s_mul_i32 s60, s60, 7
    s_add_u32 s60, s60, s61
    s_add_u32 s60, s60, s34
    s_lshl_b32 s75, s60, 16
    s_waitcnt vmcnt(8)
    s_barrier
    s_add_u32 m0, s77, 129024
    s_nop 0
    buffer_load_dwordx4 v196, s[8:11], s74 offen offset:0 sc1 lds
    buffer_load_dwordx4 v196, s[8:11], s74 offen offset:1024 sc1 lds
    buffer_load_dwordx4 v196, s[8:11], s74 offen offset:2048 sc1 lds
    buffer_load_dwordx4 v196, s[8:11], s74 offen offset:3072 sc1 lds
    s_add_u32 m0, s77, 112640
    s_nop 0
    buffer_load_dwordx4 v200, s[12:15], s75 offen offset:0 lds
    buffer_load_dwordx4 v201, s[12:15], s75 offen offset:1024 lds
    buffer_load_dwordx4 v202, s[12:15], s75 offen offset:2048 lds
    buffer_load_dwordx4 v203, s[12:15], s75 offen offset:3072 lds
    s_lshr_b32 s60, 0x14161313, s84
    s_bfe_u32 s61, s60, 0x20003
    s_add_u32 s60, s60, s72
    s_and_b32 s60, s60, 7
    s_mul_i32 s74, s60, 3
    s_add_u32 s74, s74, s61
    s_lshl_b32 s74, s74, 14
    s_add_u32 s74, s74, s79
    s_mul_i32 s60, s60, 7
    s_add_u32 s60, s60, s61
    s_add_u32 s60, s60, s34
    s_lshl_b32 s75, s60, 16
    s_waitcnt vmcnt(8)
    s_barrier
    s_add_u32 m0, s77, 16384
    s_nop 0
    buffer_load_dwordx4 v196, s[8:11], s74 offen offset:0 sc1 lds
    buffer_load_dwordx4 v196, s[8:11], s74 offen offset:1024 sc1 lds
    buffer_load_dwordx4 v196, s[8:11], s74 offen offset:2048 sc1 lds
    buffer_load_dwordx4 v196, s[8:11], s74 offen offset:3072 sc1 lds
    s_add_u32 m0, s77, 0
    s_nop 0
    buffer_load_dwordx4 v200, s[12:15], s75 offen offset:0 lds
    buffer_load_dwordx4 v201, s[12:15], s75 offen offset:1024 lds
    buffer_load_dwordx4 v202, s[12:15], s75 offen offset:2048 lds
    buffer_load_dwordx4 v203, s[12:15], s75 offen offset:3072 lds
    s_lshl_b32 s66, s4, 9
    s_add_u32 s66, s66, 16384
    s_lshl_b32 s67, s65, 8
    s_add_u32 s67, s67, 24576
    buffer_load_dwordx2 v[24:25], v28, s[28:31], s66 offen sc1
    buffer_load_dwordx2 v[26:27], v210, s[28:31], s67 offen sc1
    s_lshr_b32 s60, 0x17141415, s84
    s_bfe_u32 s61, s60, 0x20003
    s_add_u32 s60, s60, s72
    s_and_b32 s60, s60, 7
    s_mul_i32 s74, s60, 3
    s_add_u32 s74, s74, s61
    s_lshl_b32 s74, s74, 14
    s_add_u32 s74, s74, s79
    s_mul_i32 s60, s60, 7
    s_add_u32 s60, s60, s61
    s_add_u32 s60, s60, s34
    s_lshl_b32 s75, s60, 16
    s_waitcnt vmcnt(10)
    s_barrier
    s_add_u32 m0, s77, 49152
    s_nop 0
    buffer_load_dwordx4 v196, s[8:11], s74 offen offset:0 sc1 lds
    buffer_load_dwordx4 v196, s[8:11], s74 offen offset:1024 sc1 lds
    buffer_load_dwordx4 v196, s[8:11], s74 offen offset:2048 sc1 lds
    buffer_load_dwordx4 v196, s[8:11], s74 offen offset:3072 sc1 lds
    s_add_u32 m0, s77, 32768
    s_nop 0
    buffer_load_dwordx4 v200, s[12:15], s75 offen offset:0 lds
    buffer_load_dwordx4 v201, s[12:15], s75 offen offset:1024 lds
    buffer_load_dwordx4 v202, s[12:15], s75 offen offset:2048 lds
    buffer_load_dwordx4 v203, s[12:15], s75 offen offset:3072 lds
    s_lshr_b32 s60, 0x15151616, s84
    s_bfe_u32 s61, s60, 0x20003
    s_add_u32 s60, s60, s72
    s_and_b32 s60, s60, 7
    s_mul_i32 s74, s60, 3
    s_add_u32 s74, s74, s61
    s_lshl_b32 s74, s74, 14
    s_add_u32 s74, s74, s79
    s_mul_i32 s60, s60, 7
    s_add_u32 s60, s60, s61
    s_add_u32 s60, s60, s34
    s_lshl_b32 s75, s60, 16
    s_waitcnt vmcnt(10)
    s_barrier
    s_add_u32 m0, s77, 96256
    s_nop 0
    buffer_load_dwordx4 v196, s[8:11], s74 offen offset:0 sc1 lds
    buffer_load_dwordx4 v196, s[8:11], s74 offen offset:1024 sc1 lds
    buffer_load_dwordx4 v196, s[8:11], s74 offen offset:2048 sc1 lds
    buffer_load_dwordx4 v196, s[8:11], s74 offen offset:3072 sc1 lds
    s_add_u32 m0, s77, 79872
    s_nop 0
    buffer_load_dwordx4 v200, s[12:15], s75 offen offset:0 lds
    buffer_load_dwordx4 v201, s[12:15], s75 offen offset:1024 lds
    buffer_load_dwordx4 v202, s[12:15], s75 offen offset:2048 lds
    buffer_load_dwordx4 v203, s[12:15], s75 offen offset:3072 lds
    s_waitcnt vmcnt(16)
    v_cmp_ne_u64 vcc, s[94:95], v[24:25]
    s_cbranch_vccz L_rpok_14
    s_mov_b32 s62, 200000
L_rp_13:
    s_sleep 4
    buffer_load_dwordx2 v[24:25], v28, s[28:31], s66 offen sc1
    s_waitcnt vmcnt(0)
    v_cmp_ne_u64 vcc, s[94:95], v[24:25]
    s_cbranch_vccz L_rpok_14
    s_sub_u32 s62, s62, 1
    s_cmp_lg_u32 s62, 0
    s_cbranch_scc1 L_rp_13
L_rpok_14:
    v_cmp_ne_u64 vcc, s[94:95], v[26:27]
    s_cbranch_vccz L_rpok_16
    s_mov_b32 s62, 200000
L_rp_15:
    s_sleep 4
    buffer_load_dwordx2 v[26:27], v210, s[28:31], s67 offen sc1
    s_waitcnt vmcnt(0)
    v_cmp_ne_u64 vcc, s[94:95], v[26:27]
    s_cbranch_vccz L_rpok_16
    s_sub_u32 s62, s62, 1
    s_cmp_lg_u32 s62, 0
    s_cbranch_scc1 L_rp_15
L_rpok_16:
    s_or_b32 s60, s2, s33
    s_cbranch_scc1 L_noep
    s_mov_b32 s61, 0
    v_mov_b32 v248, s94
    v_mov_b32 v249, s95
    s_mov_b64 exec, 1
    buffer_store_dwordx2 v[248:249], off, s[28:31], s61 sc1
    s_mov_b64 exec, -1
L_noep:
    s_mov_b32 m0, s70
    s_nop 0
    buffer_load_dwordx4 v20, s[16:19], s69 offen offset:0 sc1 lds
    buffer_load_dwordx4 v21, s[16:19], s69 offen offset:1024 sc1 lds
    buffer_load_dwordx4 v22, s[16:19], s69 offen offset:2048 sc1 lds
    buffer_load_dwordx4 v23, s[16:19], s69 offen offset:3072 sc1 lds
    s_lshr_b32 s60, 0x16171717, s84
    s_bfe_u32 s61, s60, 0x20003
    s_add_u32 s60, s60, s72
    s_and_b32 s60, s60, 7
    s_mul_i32 s74, s60, 3
    s_add_u32 s74, s74, s61
    s_lshl_b32 s74, s74, 14
    s_add_u32 s74, s74, s79
    s_mul_i32 s60, s60, 7
    s_add_u32 s60, s60, s61
    s_add_u32 s60, s60, s34
    s_lshl_b32 s75, s60, 16
    s_waitcnt vmcnt(12)
    s_barrier
    s_add_u32 m0, s77, 129024
    s_nop 0
    buffer_load_dwordx4 v196, s[8:11], s74 offen offset:0 sc1 lds
    buffer_load_dwordx4 v196, s[8:11], s74 offen offset:1024 sc1 lds
    buffer_load_dwordx4 v196, s[8:11], s74 offen offset:2048 sc1 lds
    buffer_load_dwordx4 v196, s[8:11], s74 offen offset:3072 sc1 lds
    s_add_u32 m0, s77, 112640
    s_nop 0
    buffer_load_dwordx4 v200, s[12:15], s75 offen offset:0 lds
    buffer_load_dwordx4 v201, s[12:15], s75 offen offset:1024 lds
    buffer_load_dwordx4 v202, s[12:15], s75 offen offset:2048 lds
    buffer_load_dwordx4 v203, s[12:15], s75 offen offset:3072 lds
    s_lshl_b32 s60, s72, 1
    s_add_u32 s60, s60, s73
    s_add_u32 s60, s60, 0
    s_and_b32 s60, s60, 1
    s_add_u32 s60, s60, s76
    s_lshl_b32 s74, s60, 13
    s_add_u32 s74, s74, s71
    s_mul_i32 s60, s60, 7
    s_add_u32 s60, s60, 3
    s_lshl_b32 s75, s60, 16
    s_waitcnt vmcnt(12)
    s_barrier
    s_add_u32 m0, s77, 16384
    s_nop 0
    buffer_load_dwordx4 v196, s[8:11], s74 offen offset:0 sc1 lds
    buffer_load_dwordx4 v196, s[8:11], s74 offen offset:1024 sc1 lds
    buffer_load_dwordx4 v196, s[8:11], s74 offen offset:2048 sc1 lds
    buffer_load_dwordx4 v196, s[8:11], s74 offen offset:3072 sc1 lds
    s_add_u32 m0, s77, 0
    s_nop 0
    buffer_load_dwordx4 v200, s[12:15], s75 offen offset:0 lds
    buffer_load_dwordx4 v201, s[12:15], s75 offen offset:1024 lds
    buffer_load_dwordx4 v202, s[12:15], s75 offen offset:2048 lds
    buffer_load_dwordx4 v203, s[12:15], s75 offen offset:3072 lds
    s_add_u32 s60, s85, 0
    s_cmp_ge_u32 s60, 12
    s_cselect_b32 s61, 12, 0
    s_sub_u32 s60, s60, s61
    s_cmp_ge_u32 s60, 6
    s_cselect_b32 s61, 4, 2
    s_add_u32 s60, s60, s61
    s_lshl_b32 s74, s60, 13
    s_add_u32 s74, s74, s71
    s_mul_i32 s60, s60, 7
    s_add_u32 s60, s60, 3
    s_lshl_b32 s75, s60, 16
    s_waitcnt vmcnt(8)
    s_barrier
    s_add_u32 m0, s77, 49152
    s_nop 0
    buffer_load_dwordx4 v196, s[8:11], s74 offen offset:0 sc1 lds
    buffer_load_dwordx4 v196, s[8:11], s74 offen offset:1024 sc1 lds
    buffer_load_dwordx4 v196, s[8:11], s74 offen offset:2048 sc1 lds
    buffer_load_dwordx4 v196, s[8:11], s74 offen offset:3072 sc1 lds
    s_add_u32 m0, s78, 32768
    s_nop 0
    buffer_load_dwordx4 v204, s[12:15], s75 offen offset:0 lds
    buffer_load_dwordx4 v205, s[12:15], s75 offen offset:1024 lds
    s_add_u32 s60, s85, 2
    s_cmp_ge_u32 s60, 12
    s_cselect_b32 s61, 12, 0
    s_sub_u32 s60, s60, s61
    s_cmp_ge_u32 s60, 6
    s_cselect_b32 s61, 4, 2
    s_add_u32 s60, s60, s61
    s_lshl_b32 s74, s60, 13
    s_add_u32 s74, s74, s71
    s_mul_i32 s60, s60, 7
    s_add_u32 s60, s60, 3
    s_lshl_b32 s75, s60, 16
    s_waitcnt vmcnt(6)
    s_barrier
    s_add_u32 m0, s77, 96256
    s_nop 0
    buffer_load_dwordx4 v196, s[8:11], s74 offen offset:0 sc1 lds
    buffer_load_dwordx4 v196, s[8:11], s74 offen offset:1024 sc1 lds
    buffer_load_dwordx4 v196, s[8:11], s74 offen offset:2048 sc1 lds
    buffer_load_dwordx4 v196, s[8:11], s74 offen offset:3072 sc1 lds
    s_add_u32 m0, s78, 79872
    s_nop 0
    buffer_load_dwordx4 v204, s[12:15], s75 offen offset:0 lds
    buffer_load_dwordx4 v205, s[12:15], s75 offen offset:1024 lds
    s_add_u32 s60, s85, 4
    s_cmp_ge_u32 s60, 12
    s_cselect_b32 s61, 12, 0
    s_sub_u32 s60, s60, s61
    s_cmp_ge_u32 s60, 6
    s_cselect_b32 s61, 4, 2
    s_add_u32 s60, s60, s61
    s_lshl_b32 s74, s60, 13
    s_add_u32 s74, s74, s71
    s_mul_i32 s60, s60, 7
    s_add_u32 s60, s60, 3
    s_lshl_b32 s75, s60, 16
    s_waitcnt vmcnt(6)
    s_barrier
    s_add_u32 m0, s77, 129024
    s_nop 0
    buffer_load_dwordx4 v196, s[8:11], s74 offen offset:0 sc1 lds
    buffer_load_dwordx4 v196, s[8:11], s74 offen offset:1024 sc1 lds
    buffer_load_dwordx4 v196, s[8:11], s74 offen offset:2048 sc1 lds
    buffer_load_dwordx4 v196, s[8:11], s74 offen offset:3072 sc1 lds
    s_add_u32 m0, s78, 112640
    s_nop 0
    buffer_load_dwordx4 v204, s[12:15], s75 offen offset:0 lds
    buffer_load_dwordx4 v205, s[12:15], s75 offen offset:1024 lds
    s_add_u32 s60, s85, 6
    s_cmp_ge_u32 s60, 12
    s_cselect_b32 s61, 12, 0
    s_sub_u32 s60, s60, s61
    s_cmp_ge_u32 s60, 6
    s_cselect_b32 s61, 4, 2
    s_add_u32 s60, s60, s61
    s_lshl_b32 s74, s60, 13
    s_add_u32 s74, s74, s71
    s_mul_i32 s60, s60, 7
    s_add_u32 s60, s60, 3
    s_lshl_b32 s75, s60, 16
    s_waitcnt vmcnt(6)
    s_barrier
    s_add_u32 m0, s77, 16384
    s_nop 0
    buffer_load_dwordx4 v196, s[8:11], s74 offen offset:0 sc1 lds
    buffer_load_dwordx4 v196, s[8:11], s74 offen offset:1024 sc1 lds
    buffer_load_dwordx4 v196, s[8:11], s74 offen offset:2048 sc1 lds
    buffer_load_dwordx4 v196, s[8:11], s74 offen offset:3072 sc1 lds
    s_add_u32 m0, s78, 0
    s_nop 0
    buffer_load_dwordx4 v204, s[12:15], s75 offen offset:0 lds
    buffer_load_dwordx4 v205, s[12:15], s75 offen offset:1024 lds
    s_add_u32 s60, s85, 8
    s_cmp_ge_u32 s60, 12
    s_cselect_b32 s61, 12, 0
    s_sub_u32 s60, s60, s61
    s_cmp_ge_u32 s60, 6
    s_cselect_b32 s61, 4, 2
    s_add_u32 s60, s60, s61
    s_lshl_b32 s74, s60, 13
    s_add_u32 s74, s74, s71
    s_mul_i32 s60, s60, 7
    s_add_u32 s60, s60, 3
    s_lshl_b32 s75, s60, 16
    s_waitcnt vmcnt(6)
    s_barrier
    s_add_u32 m0, s77, 49152
    s_nop 0
    buffer_load_dwordx4 v196, s[8:11], s74 offen offset:0 sc1 lds
    buffer_load_dwordx4 v196, s[8:11], s74 offen offset:1024 sc1 lds
    buffer_load_dwordx4 v196, s[8:11], s74 offen offset:2048 sc1 lds
    buffer_load_dwordx4 v196, s[8:11], s74 offen offset:3072 sc1 lds
    s_add_u32 m0, s78, 32768
    s_nop 0
    buffer_load_dwordx4 v204, s[12:15], s75 offen offset:0 lds
    buffer_load_dwordx4 v205, s[12:15], s75 offen offset:1024 lds
    s_add_u32 s60, s85, 10
    s_cmp_ge_u32 s60, 12
    s_cselect_b32 s61, 12, 0
    s_sub_u32 s60, s60, s61
    s_cmp_ge_u32 s60, 6
    s_cselect_b32 s61, 4, 2
    s_add_u32 s60, s60, s61
    s_lshl_b32 s74, s60, 13
    s_add_u32 s74, s74, s71
    s_mul_i32 s60, s60, 7
    s_add_u32 s60, s60, 3
    s_lshl_b32 s75, s60, 16
    s_waitcnt vmcnt(6)
    s_barrier
    s_add_u32 m0, s77, 96256
    s_nop 0
    buffer_load_dwordx4 v196, s[8:11], s74 offen offset:0 sc1 lds
    buffer_load_dwordx4 v196, s[8:11], s74 offen offset:1024 sc1 lds
    buffer_load_dwordx4 v196, s[8:11], s74 offen offset:2048 sc1 lds
    buffer_load_dwordx4 v196, s[8:11], s74 offen offset:3072 sc1 lds
    s_add_u32 m0, s78, 79872
    s_nop 0
    buffer_load_dwordx4 v204, s[12:15], s75 offen offset:0 lds
    buffer_load_dwordx4 v205, s[12:15], s75 offen offset:1024 lds
    s_waitcnt vmcnt(6)
    s_barrier
    s_lshl_b32 s66, s2, 14
    s_add_u32 s66, s66, s77
    s_mov_b32 m0, s64
    s_nop 0
    buffer_load_dwordx4 v196, s[20:23], s66 offen offset:0 sc1 lds
    buffer_load_dwordx4 v196, s[20:23], s66 offen offset:1024 sc1 lds
    buffer_load_dwordx4 v196, s[20:23], s66 offen offset:2048 sc1 lds
    buffer_load_dwordx4 v196, s[20:23], s66 offen offset:3072 sc1 lds
    s_waitcnt vmcnt(4)
    s_barrier
    s_waitcnt vmcnt(0)
    s_endpgm
L_cons:
    s_lshr_b32 s66, s2, 3
    s_mul_i32 s66, s66, 20
    v_add_u32 v3, s66, v0
    v_lshlrev_b32 v3, 6, v3
    v_min_u32 v3, L_table - parallel_sum__ssm_conv_h3__dense_activation_silu__prompt_kernel, v3
    s_sub_u32 s62, s60, L_table - parallel_sum__ssm_conv_h3__dense_activation_silu__prompt_kernel
    s_subb_u32 s63, s61, 0
    v_cmp_gt_u32 vcc, 20, v0
    s_and_saveexec_b64 s[64:65], vcc
    s_cbranch_execz L_nocpf
    global_load_dword v253, v3, s[62:63]
L_nocpf:
    s_mov_b64 exec, s[64:65]
    s_waitcnt lgkmcnt(0)
    s_add_u32 s28, s58, 0x1900000
    s_addc_u32 s29, s59, 0
    s_mov_b32 s30, 0x10000
    s_mov_b32 s31, 0x20000
    s_load_dwordx2 s[96:97], s[28:29], 0
    s_and_b32 s34, s3, 1
    s_lshr_b32 s35, s3, 1
    v_mov_b32 v205, v1
    v_lshrrev_b32 v2, 4, v1
    v_bfe_u32 v3, v1, 2, 2
    v_lshl_add_u32 v3, v2, 3, v3
    v_mul_u32_u24 v3, 448, v3
    v_and_b32 v4, 3, v1
    v_lshl_add_u32 v3, v4, 3, v3
    v_add_u32 v3, 16384, v3
    v_and_b32 v2, 1, v2
    v_lshlrev_b32 v4, 5, v2
    s_lshl_b32 s60, s35, 8
    v_add_u32 v5, s60, v3
    v_add_u32 v202, v5, v4
    v_sub_u32 v203, v5, v4
    v_xor_b32 v2, s35, v2
    v_lshlrev_b32 v2, 5, v2
    v_add3_u32 v204, v3, v2, 64
    v_add_u32 v204, 128, v204
    v_and_b32 v2, 15, v1
    v_lshrrev_b32 v3, 1, v2
    v_lshrrev_b32 v4, 4, v1
    v_xor_b32 v3, v3, v4
    v_lshlrev_b32 v3, 4, v3
    v_lshl_add_u32 v3, v2, 7, v3
    s_lshl_b32 s60, s34, 13
    v_add_u32 v200, s60, v3
    v_xor_b32 v201, 64, v200
    v_mov_b32 v0, 0
    v_mov_b32 v1, 0
    v_mov_b32 v2, 0
    v_mov_b32 v3, 0
    v_mov_b32 v4, 0
    v_mov_b32 v5, 0
    v_mov_b32 v6, 0
    v_mov_b32 v7, 0
    v_mov_b32 v8, 0
    v_mov_b32 v9, 0
    v_mov_b32 v10, 0
    v_mov_b32 v11, 0
    v_mov_b32 v12, 0
    v_mov_b32 v13, 0
    v_mov_b32 v14, 0
    v_mov_b32 v15, 0
    v_mov_b32 v16, 0
    v_mov_b32 v17, 0
    v_mov_b32 v18, 0
    v_mov_b32 v19, 0
    v_mov_b32 v20, 0
    v_mov_b32 v21, 0
    v_mov_b32 v22, 0
    v_mov_b32 v23, 0
    v_mov_b32 v24, 0
    v_mov_b32 v25, 0
    v_mov_b32 v26, 0
    v_mov_b32 v27, 0
    v_mov_b32 v28, 0
    v_mov_b32 v29, 0
    v_mov_b32 v30, 0
    v_mov_b32 v31, 0
    v_mov_b32 v32, 0
    v_mov_b32 v33, 0
    v_mov_b32 v34, 0
    v_mov_b32 v35, 0
    v_mov_b32 v36, 0
    v_mov_b32 v37, 0
    v_mov_b32 v38, 0
    v_mov_b32 v39, 0
    v_mov_b32 v40, 0
    v_mov_b32 v41, 0
    v_mov_b32 v42, 0
    v_mov_b32 v43, 0
    v_mov_b32 v44, 0
    v_mov_b32 v45, 0
    v_mov_b32 v46, 0
    v_mov_b32 v47, 0
    v_mov_b32 v48, 0
    v_mov_b32 v49, 0
    v_mov_b32 v50, 0
    v_mov_b32 v51, 0
    v_mov_b32 v52, 0
    v_mov_b32 v53, 0
    v_mov_b32 v54, 0
    v_mov_b32 v55, 0
    v_mov_b32 v56, 0
    v_mov_b32 v57, 0
    v_mov_b32 v58, 0
    v_mov_b32 v59, 0
    v_mov_b32 v60, 0
    v_mov_b32 v61, 0
    v_mov_b32 v62, 0
    v_mov_b32 v63, 0
    v_mov_b32 v64, 0
    v_mov_b32 v65, 0
    v_mov_b32 v66, 0
    v_mov_b32 v67, 0
    v_mov_b32 v68, 0
    v_mov_b32 v69, 0
    v_mov_b32 v70, 0
    v_mov_b32 v71, 0
    v_mov_b32 v72, 0
    v_mov_b32 v73, 0
    v_mov_b32 v74, 0
    v_mov_b32 v75, 0
    v_mov_b32 v76, 0
    v_mov_b32 v77, 0
    v_mov_b32 v78, 0
    v_mov_b32 v79, 0
    v_mov_b32 v80, 0
    v_mov_b32 v81, 0
    v_mov_b32 v82, 0
    v_mov_b32 v83, 0
    v_mov_b32 v84, 0
    v_mov_b32 v85, 0
    v_mov_b32 v86, 0
    v_mov_b32 v87, 0
    v_mov_b32 v88, 0
    v_mov_b32 v89, 0
    v_mov_b32 v90, 0
    v_mov_b32 v91, 0
    v_mov_b32 v92, 0
    v_mov_b32 v93, 0
    v_mov_b32 v94, 0
    v_mov_b32 v95, 0
    v_mov_b32 v96, 0
    v_mov_b32 v97, 0
    v_mov_b32 v98, 0
    v_mov_b32 v99, 0
    v_mov_b32 v100, 0
    v_mov_b32 v101, 0
    v_mov_b32 v102, 0
    v_mov_b32 v103, 0
    v_mov_b32 v104, 0
    v_mov_b32 v105, 0
    v_mov_b32 v106, 0
    v_mov_b32 v107, 0
    v_mov_b32 v108, 0
    v_mov_b32 v109, 0
    v_mov_b32 v110, 0
    v_mov_b32 v111, 0
    s_mov_b32 s8, s58
    s_mov_b32 s9, s59
    s_mov_b32 s10, 0xe00000
    s_mov_b32 s11, 0x20000
    s_add_u32 s12, s58, 0x1a00000
    s_addc_u32 s13, s59, 0
    s_mov_b32 s14, 0x400000
    s_mov_b32 s15, 0x20000
    s_mov_b32 s20, s54
    s_mov_b32 s21, s55
    s_mov_b32 s22, 0x400000
    s_mov_b32 s23, 0x20000
    s_lshl_b32 s60, s3, 2
    s_add_u32 s60, s60, 161664
    v_mov_b32 v252, s60
    v_mov_b32 v211, 1
    ds_write_b32 v252, v0
    v_and_b32 v206, 48, v205
    v_lshlrev_b32 v207, 4, v205
    s_lshl_b32 s60, s34, 10
    s_add_u32 s60, s60, 161792
    v_and_b32 v208, 15, v205
    v_lshl_add_u32 v208, v208, 4, s60
    v_bfe_u32 v213, v205, 2, 2
    v_lshlrev_b32 v213, 1, v213
    v_and_b32 v214, 1, v205
    v_add_u32 v213, v213, v214
    v_and_b32 v214, 2, v205
    v_lshl_add_u32 v213, v214, 2, v213
    v_lshl_add_u32 v215, v213, 4, s60
    s_lshl_b32 s60, s35, 9
    s_add_u32 s60, s60, 160768
    v_add_u32 v209, s60, v206
    s_lshl_b32 s60, s35, 6
    s_add_u32 s60, s60, 161152
    v_add_u32 v210, s60, v206
    s_lshl_b32 s77, s3, 12
    v_add_u32 v212, s77, v207
    v_lshrrev_b32 v250, 1, v206
    v_lshl_add_u32 v214, v213, 6, v250
    v_add_u32 v214, s77, v214
    v_min_u32 v254, 31, v205
    v_lshlrev_b32 v254, 3, v254
    s_lshl_b32 s60, s4, 4
    s_add_u32 s60, s60, s5
    s_lshl_b32 s27, s60, 13
    s_add_u32 s27, s27, 12582912
    s_lshl_b32 s61, s35, 10
    s_add_u32 s27, s27, s61
    s_lshl_b32 s62, s34, 12
    s_add_u32 s27, s27, s62
    s_lshl_b32 s80, s60, 5
    s_lshl_b32 s61, s3, 3
    s_add_u32 s80, s80, s61
    s_add_u32 s81, s80, 32768
    s_add_u32 s80, s80, 16384
    s_mul_i32 s60, s60, 6
    s_add_u32 s60, s60, s35
    s_lshl_b32 s24, s60, 13
    s_add_u32 s24, s24, s62
    s_add_u32 s25, s24, 16384
    s_add_u32 s26, s24, 32768
    s_lshl_b32 s82, s4, 9
    s_and_b32 s60, s5, 8
    s_lshl_b32 s60, s60, 5
    s_add_u32 s82, s82, s60
    s_add_u32 s82, s82, 32768
    s_and_b32 s60, s5, 7
    s_lshl_b32 s60, s60, 2
    s_mov_b64 s[72:73], 0xff0
    s_lshl_b64 s[72:73], s[72:73], s60
    s_or_b32 s72, s72, s73
    s_mov_b32 s73, 0
    s_lshl_b32 s60, s2, 2
    s_add_u32 s60, s60, s3
    s_lshl_b32 s86, s60, 12
    s_xor_b32 s66, s86, 16384
    s_mul_i32 s83, s35, 79872
    s_lshl_b32 s60, s34, 15
    s_add_u32 s85, s83, s60
    s_add_u32 s85, s85, 8192
    s_add_u32 s83, s83, s62
    s_add_u32 s83, s83, 65536
    s_lshl_b32 s65, s4, 18
    s_lshl_b32 s61, s34, 17
    s_add_u32 s65, s65, s61
    s_add_u32 s65, s65, s6
    s_lshl_b32 s61, s35, 16
    s_add_u32 s65, s65, s61
    s_mul_i32 s32, s34, 9216
    s_add_u32 s32, s32, 16384
    s_mul_i32 s33, s35, 4608
    s_add_u32 s33, s33, s32
    s_lshl_b32 s64, s35, 6
    s_add_u32 s32, s32, s64
    s_add_u32 s75, s62, 16384
    v_mov_b32 v244, 0x3f803f80
    v_mov_b32 v245, 0x3f803f80
    v_mov_b32 v246, 0x3f803f80
    v_mov_b32 v247, 0x3f803f80
    s_add_u32 s16, s58, 0x1810000
    s_addc_u32 s17, s59, 0
    s_mov_b32 s18, 0x38000
    s_mov_b32 s19, 0x20000
    s_mov_b32 s68, s88
    s_add_u32 s69, s68, 2
    s_mul_i32 s60, s89, 14336
    s_mul_i32 s61, s5, 896
    s_add_u32 s60, s60, s61
    s_lshl_b32 s70, s35, 9
    s_add_u32 s70, s70, s60
    s_lshl_b32 s71, s35, 6
    s_add_u32 s71, s71, s60
    s_cmp_eq_u32 s34, 0
    s_cselect_b32 s68, s68, 15
    s_cselect_b32 s69, s69, 100
    s_waitcnt lgkmcnt(0)
    s_mul_i32 s94, s96, 0x4c957f2d
    s_mul_hi_u32 s95, s96, 0x4c957f2d
    s_mul_i32 s60, s96, 0x5851f42d
    s_add_u32 s95, s95, s60
    s_mul_i32 s60, s97, 0x4c957f2d
    s_add_u32 s95, s95, s60
    s_add_u32 s94, s94, 0xf767814f
    s_addc_u32 s95, s95, 0x14057b7e
    s_mov_b32 s74, 0
    s_mov_b32 s76, 70656
    s_mov_b32 s78, 45056
    s_mov_b32 s79, 4294851584
    s_setprio 2
    s_barrier
    ds_read_b128 v[140:143], v200 offset:0
    ds_read_b64_tr_b16 v[112:113], v202 offset:0
    ds_read_b64_tr_b16 v[114:115], v202 offset:1792
    ds_read_b128 v[144:147], v200 offset:2048
    ds_read_b128 v[148:151], v200 offset:4096
    ds_read_b128 v[152:155], v200 offset:6144
    ds_read_b64_tr_b16 v[116:117], v203 offset:32
    ds_read_b64_tr_b16 v[118:119], v203 offset:1824
    ds_read_b64_tr_b16 v[120:121], v202 offset:64
    ds_read_b64_tr_b16 v[122:123], v202 offset:1856
    ds_read_b64_tr_b16 v[124:125], v203 offset:96
    ds_read_b64_tr_b16 v[126:127], v203 offset:1888
    ds_read_b64_tr_b16 v[128:129], v202 offset:128
    ds_read_b64_tr_b16 v[130:131], v202 offset:1920
    ds_read_b64_tr_b16 v[132:133], v203 offset:160
    ds_read_b64_tr_b16 v[134:135], v203 offset:1952
    ds_read_b64_tr_b16 v[136:137], v204 offset:0
    ds_read_b64_tr_b16 v[138:139], v204 offset:1792
    .p2align 6
L_cloop:
    s_waitcnt lgkmcnt(0)
    v_mfma_f32_16x16x32_bf16 v[0:3], v[112:115], v[140:143], v[0:3]
    ds_read_b128 v[184:187], v201 offset:0
    v_mfma_f32_16x16x32_bf16 v[4:7], v[112:115], v[144:147], v[4:7]
    ds_read_b64_tr_b16 v[156:157], v202 offset:14336
    v_mfma_f32_16x16x32_bf16 v[8:11], v[112:115], v[148:151], v[8:11]
    ds_read_b64_tr_b16 v[158:159], v202 offset:16128
    v_mfma_f32_16x16x32_bf16 v[12:15], v[112:115], v[152:155], v[12:15]
    ds_read_b128 v[188:191], v201 offset:2048
    v_mfma_f32_16x16x32_bf16 v[28:31], v[116:119], v[152:155], v[28:31]
    ds_read_b128 v[192:195], v201 offset:4096
    v_mfma_f32_16x16x32_bf16 v[24:27], v[116:119], v[148:151], v[24:27]
    ds_read_b128 v[196:199], v201 offset:6144
    v_mfma_f32_16x16x32_bf16 v[20:23], v[116:119], v[144:147], v[20:23]
    ds_read_b64_tr_b16 v[160:161], v203 offset:14368
    v_mfma_f32_16x16x32_bf16 v[16:19], v[116:119], v[140:143], v[16:19]
    ds_read_b64_tr_b16 v[162:163], v203 offset:16160
    v_mfma_f32_16x16x32_bf16 v[32:35], v[120:123], v[140:143], v[32:35]
    ds_read_b64_tr_b16 v[164:165], v202 offset:14400
    v_mfma_f32_16x16x32_bf16 v[36:39], v[120:123], v[144:147], v[36:39]
    ds_read_b64_tr_b16 v[166:167], v202 offset:16192
    v_mfma_f32_16x16x32_bf16 v[40:43], v[120:123], v[148:151], v[40:43]
    ds_read_b64_tr_b16 v[168:169], v203 offset:14432
    v_mfma_f32_16x16x32_bf16 v[44:47], v[120:123], v[152:155], v[44:47]
    ds_read_b64_tr_b16 v[170:171], v203 offset:16224
    v_mfma_f32_16x16x32_bf16 v[60:63], v[124:127], v[152:155], v[60:63]
    ds_read_b64_tr_b16 v[172:173], v202 offset:14464
    v_mfma_f32_16x16x32_bf16 v[56:59], v[124:127], v[148:151], v[56:59]
    ds_read_b64_tr_b16 v[174:175], v202 offset:16256
    v_mfma_f32_16x16x32_bf16 v[52:55], v[124:127], v[144:147], v[52:55]
    ds_read_b64_tr_b16 v[176:177], v203 offset:14496
    v_mfma_f32_16x16x32_bf16 v[48:51], v[124:127], v[140:143], v[48:51]
    ds_read_b64_tr_b16 v[178:179], v203 offset:16288
    v_mfma_f32_16x16x32_bf16 v[64:67], v[128:131], v[140:143], v[64:67]
    ds_read_b64_tr_b16 v[180:181], v204 offset:14336
    v_mfma_f32_16x16x32_bf16 v[68:71], v[128:131], v[144:147], v[68:71]
    ds_read_b64_tr_b16 v[182:183], v204 offset:16128
    v_mfma_f32_16x16x32_bf16 v[72:75], v[128:131], v[148:151], v[72:75]
    v_add_u32 v200, s76, v200
    v_mfma_f32_16x16x32_bf16 v[76:79], v[128:131], v[152:155], v[76:79]
    v_add_u32 v201, s76, v201
    v_mfma_f32_16x16x32_bf16 v[92:95], v[132:135], v[152:155], v[92:95]
    v_add_u32 v202, s76, v202
    v_mfma_f32_16x16x32_bf16 v[88:91], v[132:135], v[148:151], v[88:91]
    v_add_u32 v203, s76, v203
    v_mfma_f32_16x16x32_bf16 v[84:87], v[132:135], v[144:147], v[84:87]
    v_add_u32 v204, s76, v204
    v_mfma_f32_16x16x32_bf16 v[80:83], v[132:135], v[140:143], v[80:83]
    s_cmp_eq_u32 s74, s68
    v_mfma_f32_16x16x32_bf16 v[96:99], v[136:139], v[140:143], v[96:99]
    v_mfma_f32_16x16x32_bf16 v[100:103], v[136:139], v[144:147], v[100:103]
    v_mfma_f32_16x16x32_bf16 v[104:107], v[136:139], v[148:151], v[104:107]
    v_mfma_f32_16x16x32_bf16 v[108:111], v[136:139], v[152:155], v[108:111]
    s_waitcnt lgkmcnt(0)
    s_barrier
    s_cbranch_scc1 L_c_cs
L_c_csback:
    v_mfma_f32_16x16x32_bf16 v[0:3], v[156:159], v[184:187], v[0:3]
    ds_read_b128 v[140:143], v200 offset:0
    v_mfma_f32_16x16x32_bf16 v[4:7], v[156:159], v[188:191], v[4:7]
    ds_read_b64_tr_b16 v[112:113], v202 offset:0
    v_mfma_f32_16x16x32_bf16 v[8:11], v[156:159], v[192:195], v[8:11]
    ds_read_b64_tr_b16 v[114:115], v202 offset:1792
    v_mfma_f32_16x16x32_bf16 v[12:15], v[156:159], v[196:199], v[12:15]
    ds_read_b128 v[144:147], v200 offset:2048
    v_mfma_f32_16x16x32_bf16 v[28:31], v[160:163], v[196:199], v[28:31]
    ds_read_b128 v[148:151], v200 offset:4096
    v_mfma_f32_16x16x32_bf16 v[24:27], v[160:163], v[192:195], v[24:27]
    ds_read_b128 v[152:155], v200 offset:6144
    v_mfma_f32_16x16x32_bf16 v[20:23], v[160:163], v[188:191], v[20:23]
    ds_read_b64_tr_b16 v[116:117], v203 offset:32
    v_mfma_f32_16x16x32_bf16 v[16:19], v[160:163], v[184:187], v[16:19]
    ds_read_b64_tr_b16 v[118:119], v203 offset:1824
    v_mfma_f32_16x16x32_bf16 v[32:35], v[164:167], v[184:187], v[32:35]
    ds_read_b64_tr_b16 v[120:121], v202 offset:64
    v_mfma_f32_16x16x32_bf16 v[36:39], v[164:167], v[188:191], v[36:39]
    ds_read_b64_tr_b16 v[122:123], v202 offset:1856
    v_mfma_f32_16x16x32_bf16 v[40:43], v[164:167], v[192:195], v[40:43]
    ds_read_b64_tr_b16 v[124:125], v203 offset:96
    v_mfma_f32_16x16x32_bf16 v[44:47], v[164:167], v[196:199], v[44:47]
    ds_read_b64_tr_b16 v[126:127], v203 offset:1888
    v_mfma_f32_16x16x32_bf16 v[60:63], v[168:171], v[196:199], v[60:63]
    ds_read_b64_tr_b16 v[128:129], v202 offset:128
    v_mfma_f32_16x16x32_bf16 v[56:59], v[168:171], v[192:195], v[56:59]
    ds_read_b64_tr_b16 v[130:131], v202 offset:1920
    v_mfma_f32_16x16x32_bf16 v[52:55], v[168:171], v[188:191], v[52:55]
    ds_read_b64_tr_b16 v[132:133], v203 offset:160
    v_mfma_f32_16x16x32_bf16 v[48:51], v[168:171], v[184:187], v[48:51]
    ds_read_b64_tr_b16 v[134:135], v203 offset:1952
    v_mfma_f32_16x16x32_bf16 v[64:67], v[172:175], v[184:187], v[64:67]
    ds_read_b64_tr_b16 v[136:137], v204 offset:0
    v_mfma_f32_16x16x32_bf16 v[68:71], v[172:175], v[188:191], v[68:71]
    ds_read_b64_tr_b16 v[138:139], v204 offset:1792
    v_mfma_f32_16x16x32_bf16 v[72:75], v[172:175], v[192:195], v[72:75]
    s_cmp_eq_u32 s74, s69
    s_cbranch_scc1 L_c_fl
L_c_flback:
    v_mfma_f32_16x16x32_bf16 v[76:79], v[172:175], v[196:199], v[76:79]
    s_mov_b32 s61, s76
    s_mov_b32 s76, s78
    v_mfma_f32_16x16x32_bf16 v[92:95], v[176:179], v[196:199], v[92:95]
    s_mov_b32 s78, s79
    s_mov_b32 s79, s61
    v_mfma_f32_16x16x32_bf16 v[88:91], v[176:179], v[192:195], v[88:91]
    s_add_u32 s74, s74, 1
    v_mfma_f32_16x16x32_bf16 v[84:87], v[176:179], v[188:191], v[84:87]
    v_mfma_f32_16x16x32_bf16 v[80:83], v[176:179], v[184:187], v[80:83]
    v_mfma_f32_16x16x32_bf16 v[96:99], v[180:183], v[184:187], v[96:99]
    v_mfma_f32_16x16x32_bf16 v[100:103], v[180:183], v[188:191], v[100:103]
    v_mfma_f32_16x16x32_bf16 v[104:107], v[180:183], v[192:195], v[104:107]
    v_mfma_f32_16x16x32_bf16 v[108:111], v[180:183], v[196:199], v[108:111]
    s_branch L_cloop
L_c_last:
    v_mfma_f32_16x16x32_bf16 v[0:3], v[156:159], v[184:187], v[0:3]
    ds_read_b128 v[112:115], v208 offset:0
    v_add_u32 v204, v206, v213
    v_mfma_f32_16x16x32_bf16 v[4:7], v[156:159], v[188:191], v[4:7]
    ds_read_b128 v[116:119], v208 offset:256
    v_lshl_add_u32 v204, v204, 4, s75
    v_mfma_f32_16x16x32_bf16 v[8:11], v[156:159], v[192:195], v[8:11]
    ds_read_b128 v[120:123], v208 offset:512
    v_lshrrev_b32 v246, 2, v205
    v_mfma_f32_16x16x32_bf16 v[12:15], v[156:159], v[196:199], v[12:15]
    ds_read_b128 v[124:127], v208 offset:768
    v_and_b32 v247, 3, v205
    v_mfma_f32_16x16x32_bf16 v[28:31], v[160:163], v[196:199], v[28:31]
    ds_read_b128 v[128:131], v209 offset:0
    v_lshlrev_b32 v247, 3, v247
    v_mfma_f32_16x16x32_bf16 v[24:27], v[160:163], v[192:195], v[24:27]
    ds_read_b128 v[132:135], v209 offset:64
    v_and_b32 v245, 7, v246
    v_mfma_f32_16x16x32_bf16 v[20:23], v[160:163], v[188:191], v[20:23]
    ds_read_b128 v[136:139], v209 offset:128
    v_lshlrev_b32 v245, 5, v245
    v_mfma_f32_16x16x32_bf16 v[16:19], v[160:163], v[184:187], v[16:19]
    ds_read_b128 v[140:143], v209 offset:192
    v_xor_b32 v245, s64, v245
    v_mfma_f32_16x16x32_bf16 v[32:35], v[164:167], v[184:187], v[32:35]
    ds_read_b128 v[144:147], v209 offset:256
    v_lshl_add_u32 v245, v246, 8, v245
    v_mfma_f32_16x16x32_bf16 v[36:39], v[164:167], v[188:191], v[36:39]
    ds_read_b128 v[148:151], v209 offset:320
    v_add_u32 v200, v245, v247
    v_mfma_f32_16x16x32_bf16 v[40:43], v[164:167], v[192:195], v[40:43]
    ds_read_b128 v[152:155], v210
    v_xor_b32 v201, 32, v200
    v_mfma_f32_16x16x32_bf16 v[44:47], v[164:167], v[196:199], v[44:47]
    ds_read_b64 v[216:217], v214 offset:49152
    v_xor_b32 v202, 128, v200
    v_mfma_f32_16x16x32_bf16 v[60:63], v[168:171], v[196:199], v[60:63]
    ds_read_b64 v[224:225], v214 offset:49184
    v_xor_b32 v203, 160, v200
    v_mfma_f32_16x16x32_bf16 v[56:59], v[168:171], v[192:195], v[56:59]
    ds_read_b64 v[218:219], v214 offset:50176
    v_add_u32 v240, 79872, v200
    v_mfma_f32_16x16x32_bf16 v[52:55], v[168:171], v[188:191], v[52:55]
    ds_read_b64 v[226:227], v214 offset:50208
    v_add_u32 v241, 79872, v201
    v_mfma_f32_16x16x32_bf16 v[48:51], v[168:171], v[184:187], v[48:51]
    ds_read_b64 v[220:221], v214 offset:51200
    v_add_u32 v242, 79872, v202
    v_mfma_f32_16x16x32_bf16 v[64:67], v[172:175], v[184:187], v[64:67]
    ds_read_b64 v[228:229], v214 offset:51232
    v_add_u32 v243, 79872, v203
    v_mfma_f32_16x16x32_bf16 v[68:71], v[172:175], v[188:191], v[68:71]
    ds_read_b64 v[222:223], v214 offset:52224
    v_add_u32 v244, 79872, v204
    v_mfma_f32_16x16x32_bf16 v[72:75], v[172:175], v[192:195], v[72:75]
    ds_read_b64 v[230:231], v214 offset:52256
    v_mfma_f32_16x16x32_bf16 v[76:79], v[172:175], v[196:199], v[76:79]
    ds_read2_b32 v[232:233], v215 offset0:0 offset1:3
    v_mfma_f32_16x16x32_bf16 v[92:95], v[176:179], v[196:199], v[92:95]
    ds_read2_b32 v[234:235], v215 offset0:64 offset1:67
    v_mfma_f32_16x16x32_bf16 v[88:91], v[176:179], v[192:195], v[88:91]
    ds_read2_b32 v[236:237], v215 offset0:128 offset1:131
    v_mfma_f32_16x16x32_bf16 v[84:87], v[176:179], v[188:191], v[84:87]
    ds_read2_b32 v[238:239], v215 offset0:192 offset1:195
    v_mfma_f32_16x16x32_bf16 v[80:83], v[176:179], v[184:187], v[80:83]
    v_mfma_f32_16x16x32_bf16 v[96:99], v[180:183], v[184:187], v[96:99]
    v_mfma_f32_16x16x32_bf16 v[100:103], v[180:183], v[188:191], v[100:103]
    v_mfma_f32_16x16x32_bf16 v[104:107], v[180:183], v[192:195], v[104:107]
    v_mfma_f32_16x16x32_bf16 v[108:111], v[180:183], v[196:199], v[108:111]
    v_mov_b32 v164, -1
    v_mov_b32 v165, -1
    v_mov_b32 v166, -1
    v_mov_b32 v167, -1
    buffer_store_dwordx4 v[164:167], v207, s[12:15], s86 offen offset:0 sc1
    buffer_store_dwordx4 v[164:167], v207, s[12:15], s86 offen offset:1024 sc1
    buffer_store_dwordx4 v[164:167], v207, s[12:15], s86 offen offset:2048 sc1
    buffer_store_dwordx4 v[164:167], v207, s[12:15], s86 offen offset:3072 sc1
    s_waitcnt lgkmcnt(0)
    v_mov_b32 v188, v113
    v_mov_b32 v190, v117
    v_mov_b32 v192, v121
    v_mov_b32 v194, v125
    .p2align 3
    v_pk_fma_f32 v[0:1], v[128:129], v[112:113], v[0:1] op_sel_hi:[1,0,1] neg_lo:[1,0,0] neg_hi:[1,0,0]
    v_pk_fma_f32 v[2:3], v[130:131], v[112:113], v[2:3] op_sel_hi:[1,0,1] neg_lo:[1,0,0] neg_hi:[1,0,0]
    v_pk_fma_f32 v[16:17], v[132:133], v[112:113], v[16:17] op_sel_hi:[1,0,1] neg_lo:[1,0,0] neg_hi:[1,0,0]
    v_pk_fma_f32 v[18:19], v[134:135], v[112:113], v[18:19] op_sel_hi:[1,0,1] neg_lo:[1,0,0] neg_hi:[1,0,0]
    v_pk_mul_f32 v[156:157], v[0:1], v[114:115] op_sel_hi:[1,0]
    v_pk_mul_f32 v[158:159], v[2:3], v[114:115] op_sel_hi:[1,0]
    v_pk_mul_f32 v[160:161], v[16:17], v[114:115] op_sel_hi:[1,0]
    v_pk_mul_f32 v[162:163], v[18:19], v[114:115] op_sel_hi:[1,0]
    v_exp_f32 v156, v156
    v_exp_f32 v157, v157
    v_exp_f32 v158, v158
    v_exp_f32 v159, v159
    v_exp_f32 v160, v160
    v_exp_f32 v161, v161
    v_exp_f32 v162, v162
    v_exp_f32 v163, v163
    v_pk_fma_f32 v[156:157], v[156:157], v[188:189], v[188:189] op_sel_hi:[1,0,0]
    v_pk_fma_f32 v[158:159], v[158:159], v[188:189], v[188:189] op_sel_hi:[1,0,0]
    v_pk_fma_f32 v[160:161], v[160:161], v[188:189], v[188:189] op_sel_hi:[1,0,0]
    v_pk_fma_f32 v[162:163], v[162:163], v[188:189], v[188:189] op_sel_hi:[1,0,0]
    v_rcp_f32 v156, v156
    v_rcp_f32 v157, v157
    v_rcp_f32 v158, v158
    v_rcp_f32 v159, v159
    v_rcp_f32 v160, v160
    v_rcp_f32 v161, v161
    v_rcp_f32 v162, v162
    v_rcp_f32 v163, v163
    v_pk_mul_f32 v[156:157], v[156:157], v[0:1]
    v_pk_mul_f32 v[158:159], v[158:159], v[2:3]
    v_pk_mul_f32 v[160:161], v[160:161], v[16:17]
    v_pk_mul_f32 v[162:163], v[162:163], v[18:19]
    v_cvt_pk_bf16_f32 v172, v156, v157
    v_cvt_pk_bf16_f32 v173, v158, v159
    v_cvt_pk_bf16_f32 v174, v160, v161
    v_cvt_pk_bf16_f32 v175, v162, v163
    buffer_store_dwordx4 v[172:175], v207, s[8:11], s24 offen offset:0 sc1
    ds_write_b128 v212, v[172:175] offset:16384
    v_pk_fma_f32 v[4:5], v[128:129], v[116:117], v[4:5] op_sel_hi:[1,0,1] neg_lo:[1,0,0] neg_hi:[1,0,0]
    v_pk_fma_f32 v[6:7], v[130:131], v[116:117], v[6:7] op_sel_hi:[1,0,1] neg_lo:[1,0,0] neg_hi:[1,0,0]
    v_pk_fma_f32 v[20:21], v[132:133], v[116:117], v[20:21] op_sel_hi:[1,0,1] neg_lo:[1,0,0] neg_hi:[1,0,0]
    v_pk_fma_f32 v[22:23], v[134:135], v[116:117], v[22:23] op_sel_hi:[1,0,1] neg_lo:[1,0,0] neg_hi:[1,0,0]
    v_pk_mul_f32 v[156:157], v[4:5], v[118:119] op_sel_hi:[1,0]
    v_pk_mul_f32 v[158:159], v[6:7], v[118:119] op_sel_hi:[1,0]
    v_pk_mul_f32 v[160:161], v[20:21], v[118:119] op_sel_hi:[1,0]
    v_pk_mul_f32 v[162:163], v[22:23], v[118:119] op_sel_hi:[1,0]
    v_exp_f32 v156, v156
    v_exp_f32 v157, v157
    v_exp_f32 v158, v158
    v_exp_f32 v159, v159
    v_exp_f32 v160, v160
    v_exp_f32 v161, v161
    v_exp_f32 v162, v162
    v_exp_f32 v163, v163
    v_pk_fma_f32 v[156:157], v[156:157], v[190:191], v[190:191] op_sel_hi:[1,0,0]
    v_pk_fma_f32 v[158:159], v[158:159], v[190:191], v[190:191] op_sel_hi:[1,0,0]
    v_pk_fma_f32 v[160:161], v[160:161], v[190:191], v[190:191] op_sel_hi:[1,0,0]
    v_pk_fma_f32 v[162:163], v[162:163], v[190:191], v[190:191] op_sel_hi:[1,0,0]
    v_rcp_f32 v156, v156
    v_rcp_f32 v157, v157
    v_rcp_f32 v158, v158
    v_rcp_f32 v159, v159
    v_rcp_f32 v160, v160
    v_rcp_f32 v161, v161
    v_rcp_f32 v162, v162
    v_rcp_f32 v163, v163
    v_pk_mul_f32 v[156:157], v[156:157], v[4:5]
    v_pk_mul_f32 v[158:159], v[158:159], v[6:7]
    v_pk_mul_f32 v[160:161], v[160:161], v[20:21]
    v_pk_mul_f32 v[162:163], v[162:163], v[22:23]
    v_cvt_pk_bf16_f32 v176, v156, v157
    v_cvt_pk_bf16_f32 v177, v158, v159
    v_cvt_pk_bf16_f32 v178, v160, v161
    v_cvt_pk_bf16_f32 v179, v162, v163
    buffer_store_dwordx4 v[176:179], v207, s[8:11], s24 offen offset:1024 sc1
    ds_write_b128 v212, v[176:179] offset:17408
    v_pk_fma_f32 v[8:9], v[128:129], v[120:121], v[8:9] op_sel_hi:[1,0,1] neg_lo:[1,0,0] neg_hi:[1,0,0]
    v_pk_fma_f32 v[10:11], v[130:131], v[120:121], v[10:11] op_sel_hi:[1,0,1] neg_lo:[1,0,0] neg_hi:[1,0,0]
    v_pk_fma_f32 v[24:25], v[132:133], v[120:121], v[24:25] op_sel_hi:[1,0,1] neg_lo:[1,0,0] neg_hi:[1,0,0]
    v_pk_fma_f32 v[26:27], v[134:135], v[120:121], v[26:27] op_sel_hi:[1,0,1] neg_lo:[1,0,0] neg_hi:[1,0,0]
    v_pk_mul_f32 v[156:157], v[8:9], v[122:123] op_sel_hi:[1,0]
    v_pk_mul_f32 v[158:159], v[10:11], v[122:123] op_sel_hi:[1,0]
    v_pk_mul_f32 v[160:161], v[24:25], v[122:123] op_sel_hi:[1,0]
    v_pk_mul_f32 v[162:163], v[26:27], v[122:123] op_sel_hi:[1,0]
    v_exp_f32 v156, v156
    v_exp_f32 v157, v157
    v_exp_f32 v158, v158
    v_exp_f32 v159, v159
    v_exp_f32 v160, v160
    v_exp_f32 v161, v161
    v_exp_f32 v162, v162
    v_exp_f32 v163, v163
    v_pk_fma_f32 v[156:157], v[156:157], v[192:193], v[192:193] op_sel_hi:[1,0,0]
    v_pk_fma_f32 v[158:159], v[158:159], v[192:193], v[192:193] op_sel_hi:[1,0,0]
    v_pk_fma_f32 v[160:161], v[160:161], v[192:193], v[192:193] op_sel_hi:[1,0,0]
    v_pk_fma_f32 v[162:163], v[162:163], v[192:193], v[192:193] op_sel_hi:[1,0,0]
    v_rcp_f32 v156, v156
    v_rcp_f32 v157, v157
    v_rcp_f32 v158, v158
    v_rcp_f32 v159, v159
    v_rcp_f32 v160, v160
    v_rcp_f32 v161, v161
    v_rcp_f32 v162, v162
    v_rcp_f32 v163, v163
    v_pk_mul_f32 v[156:157], v[156:157], v[8:9]
    v_pk_mul_f32 v[158:159], v[158:159], v[10:11]
    v_pk_mul_f32 v[160:161], v[160:161], v[24:25]
    v_pk_mul_f32 v[162:163], v[162:163], v[26:27]
    v_cvt_pk_bf16_f32 v180, v156, v157
    v_cvt_pk_bf16_f32 v181, v158, v159
    v_cvt_pk_bf16_f32 v182, v160, v161
    v_cvt_pk_bf16_f32 v183, v162, v163
    buffer_store_dwordx4 v[180:183], v207, s[8:11], s24 offen offset:2048 sc1
    ds_write_b128 v212, v[180:183] offset:18432
    ds_write_b32 v252, v211
    v_sub_f32 v112, 0, v112
    v_sub_f32 v116, 0, v116
    v_sub_f32 v120, 0, v120
    v_sub_f32 v124, 0, v124
    v_fmac_f32 v12, v128, v124
    v_fmac_f32 v13, v129, v124
    v_fmac_f32 v14, v130, v124
    v_fmac_f32 v15, v131, v124
    v_fmac_f32 v28, v132, v124
    v_fmac_f32 v29, v133, v124
    v_fmac_f32 v30, v134, v124
    v_fmac_f32 v31, v135, v124
    v_mul_f32 v156, v12, v126
    v_mul_f32 v157, v13, v126
    v_mul_f32 v158, v14, v126
    v_mul_f32 v159, v15, v126
    v_mul_f32 v160, v28, v126
    v_mul_f32 v161, v29, v126
    v_mul_f32 v162, v30, v126
    v_mul_f32 v163, v31, v126
    v_exp_f32 v156, v156
    v_exp_f32 v157, v157
    v_exp_f32 v158, v158
    v_exp_f32 v159, v159
    v_exp_f32 v160, v160
    v_exp_f32 v161, v161
    v_exp_f32 v162, v162
    v_exp_f32 v163, v163
    v_fma_f32 v156, v156, v125, v125
    v_fma_f32 v157, v157, v125, v125
    v_fma_f32 v158, v158, v125, v125
    v_fma_f32 v159, v159, v125, v125
    v_fma_f32 v160, v160, v125, v125
    v_fma_f32 v161, v161, v125, v125
    v_fma_f32 v162, v162, v125, v125
    v_fma_f32 v163, v163, v125, v125
    v_rcp_f32 v156, v156
    v_rcp_f32 v157, v157
    v_rcp_f32 v158, v158
    v_rcp_f32 v159, v159
    v_rcp_f32 v160, v160
    v_rcp_f32 v161, v161
    v_rcp_f32 v162, v162
    v_rcp_f32 v163, v163
    v_mul_f32 v156, v156, v12
    v_mul_f32 v157, v157, v13
    v_mul_f32 v158, v158, v14
    v_mul_f32 v159, v159, v15
    v_mul_f32 v160, v160, v28
    v_mul_f32 v161, v161, v29
    v_mul_f32 v162, v162, v30
    v_mul_f32 v163, v163, v31
    v_cvt_pk_bf16_f32 v184, v156, v157
    v_cvt_pk_bf16_f32 v185, v158, v159
    v_cvt_pk_bf16_f32 v186, v160, v161
    v_cvt_pk_bf16_f32 v187, v162, v163
    buffer_store_dwordx4 v[184:187], v207, s[8:11], s24 offen offset:3072 sc1
    ds_write_b128 v212, v[184:187] offset:19456
    v_fmac_f32 v32, v136, v112
    v_fmac_f32 v33, v137, v112
    v_fmac_f32 v34, v138, v112
    v_fmac_f32 v35, v139, v112
    v_fmac_f32 v48, v140, v112
    v_fmac_f32 v49, v141, v112
    v_fmac_f32 v50, v142, v112
    v_fmac_f32 v51, v143, v112
    v_mul_f32 v156, v32, v114
    v_mul_f32 v157, v33, v114
    v_mul_f32 v158, v34, v114
    v_mul_f32 v159, v35, v114
    v_mul_f32 v160, v48, v114
    v_mul_f32 v161, v49, v114
    v_mul_f32 v162, v50, v114
    v_mul_f32 v163, v51, v114
    v_exp_f32 v156, v156
    v_exp_f32 v157, v157
    v_exp_f32 v158, v158
    v_exp_f32 v159, v159
    v_exp_f32 v160, v160
    v_exp_f32 v161, v161
    v_exp_f32 v162, v162
    v_exp_f32 v163, v163
    v_fma_f32 v156, v156, v113, v113
    v_fma_f32 v157, v157, v113, v113
    v_fma_f32 v158, v158, v113, v113
    v_fma_f32 v159, v159, v113, v113
    v_fma_f32 v160, v160, v113, v113
    v_fma_f32 v161, v161, v113, v113
    v_fma_f32 v162, v162, v113, v113
    v_fma_f32 v163, v163, v113, v113
    v_rcp_f32 v156, v156
    v_rcp_f32 v157, v157
    v_rcp_f32 v158, v158
    v_rcp_f32 v159, v159
    v_rcp_f32 v160, v160
    v_rcp_f32 v161, v161
    v_rcp_f32 v162, v162
    v_rcp_f32 v163, v163
    v_mul_f32 v156, v156, v32
    v_mul_f32 v157, v157, v33
    v_mul_f32 v158, v158, v34
    v_mul_f32 v159, v159, v35
    v_mul_f32 v160, v160, v48
    v_mul_f32 v161, v161, v49
    v_mul_f32 v162, v162, v50
    v_mul_f32 v163, v163, v51
    v_cvt_pk_bf16_f32 v172, v156, v157
    v_cvt_pk_bf16_f32 v173, v158, v159
    v_cvt_pk_bf16_f32 v174, v160, v161
    v_cvt_pk_bf16_f32 v175, v162, v163
    buffer_store_dwordx4 v[172:175], v207, s[8:11], s25 offen offset:0 sc1
    ds_write_b128 v212, v[172:175] offset:49152
    v_fmac_f32 v36, v136, v116
    v_fmac_f32 v37, v137, v116
    v_fmac_f32 v38, v138, v116
    v_fmac_f32 v39, v139, v116
    v_fmac_f32 v52, v140, v116
    v_fmac_f32 v53, v141, v116
    v_fmac_f32 v54, v142, v116
    v_fmac_f32 v55, v143, v116
    v_mul_f32 v156, v36, v118
    v_mul_f32 v157, v37, v118
    v_mul_f32 v158, v38, v118
    v_mul_f32 v159, v39, v118
    v_mul_f32 v160, v52, v118
    v_mul_f32 v161, v53, v118
    v_mul_f32 v162, v54, v118
    v_mul_f32 v163, v55, v118
    v_exp_f32 v156, v156
    v_exp_f32 v157, v157
    v_exp_f32 v158, v158
    v_exp_f32 v159, v159
    v_exp_f32 v160, v160
    v_exp_f32 v161, v161
    v_exp_f32 v162, v162
    v_exp_f32 v163, v163
    v_fma_f32 v156, v156, v117, v117
    v_fma_f32 v157, v157, v117, v117
    v_fma_f32 v158, v158, v117, v117
    v_fma_f32 v159, v159, v117, v117
    v_fma_f32 v160, v160, v117, v117
    v_fma_f32 v161, v161, v117, v117
    v_fma_f32 v162, v162, v117, v117
    v_fma_f32 v163, v163, v117, v117
    v_rcp_f32 v156, v156
    v_rcp_f32 v157, v157
    v_rcp_f32 v158, v158
    v_rcp_f32 v159, v159
    v_rcp_f32 v160, v160
    v_rcp_f32 v161, v161
    v_rcp_f32 v162, v162
    v_rcp_f32 v163, v163
    v_mul_f32 v156, v156, v36
    v_mul_f32 v157, v157, v37
    v_mul_f32 v158, v158, v38
    v_mul_f32 v159, v159, v39
    v_mul_f32 v160, v160, v52
    v_mul_f32 v161, v161, v53
    v_mul_f32 v162, v162, v54
    v_mul_f32 v163, v163, v55
    v_cvt_pk_bf16_f32 v176, v156, v157
    v_cvt_pk_bf16_f32 v177, v158, v159
    v_cvt_pk_bf16_f32 v178, v160, v161
    v_cvt_pk_bf16_f32 v179, v162, v163
    buffer_store_dwordx4 v[176:179], v207, s[8:11], s25 offen offset:1024 sc1
    ds_write_b128 v212, v[176:179] offset:50176
    v_fmac_f32 v40, v136, v120
    v_fmac_f32 v41, v137, v120
    v_fmac_f32 v42, v138, v120
    v_fmac_f32 v43, v139, v120
    v_fmac_f32 v56, v140, v120
    v_fmac_f32 v57, v141, v120
    v_fmac_f32 v58, v142, v120
    v_fmac_f32 v59, v143, v120
    v_mul_f32 v156, v40, v122
    v_mul_f32 v157, v41, v122
    v_mul_f32 v158, v42, v122
    v_mul_f32 v159, v43, v122
    v_mul_f32 v160, v56, v122
    v_mul_f32 v161, v57, v122
    v_mul_f32 v162, v58, v122
    v_mul_f32 v163, v59, v122
    v_exp_f32 v156, v156
    v_exp_f32 v157, v157
    v_exp_f32 v158, v158
    v_exp_f32 v159, v159
    v_exp_f32 v160, v160
    v_exp_f32 v161, v161
    v_exp_f32 v162, v162
    v_exp_f32 v163, v163
    v_fma_f32 v156, v156, v121, v121
    v_fma_f32 v157, v157, v121, v121
    v_fma_f32 v158, v158, v121, v121
    v_fma_f32 v159, v159, v121, v121
    v_fma_f32 v160, v160, v121, v121
    v_fma_f32 v161, v161, v121, v121
    v_fma_f32 v162, v162, v121, v121
    v_fma_f32 v163, v163, v121, v121
    v_rcp_f32 v156, v156
    v_rcp_f32 v157, v157
    v_rcp_f32 v158, v158
    v_rcp_f32 v159, v159
    v_rcp_f32 v160, v160
    v_rcp_f32 v161, v161
    v_rcp_f32 v162, v162
    v_rcp_f32 v163, v163
    v_mul_f32 v156, v156, v40
    v_mul_f32 v157, v157, v41
    v_mul_f32 v158, v158, v42
    v_mul_f32 v159, v159, v43
    v_mul_f32 v160, v160, v56
    v_mul_f32 v161, v161, v57
    v_mul_f32 v162, v162, v58
    v_mul_f32 v163, v163, v59
    v_cvt_pk_bf16_f32 v180, v156, v157
    v_cvt_pk_bf16_f32 v181, v158, v159
    v_cvt_pk_bf16_f32 v182, v160, v161
    v_cvt_pk_bf16_f32 v183, v162, v163
    buffer_store_dwordx4 v[180:183], v207, s[8:11], s25 offen offset:2048 sc1
    ds_write_b128 v212, v[180:183] offset:51200
    s_waitcnt vmcnt(3)
    s_nop 0
    v_mov_b32 v248, s94
    v_mov_b32 v249, s95
    s_mov_b64 exec, 1
    buffer_store_dwordx2 v[248:249], off, s[28:31], s81 sc1
    s_mov_b64 exec, -1
    v_fmac_f32 v44, v136, v124
    v_fmac_f32 v45, v137, v124
    v_fmac_f32 v46, v138, v124
    v_fmac_f32 v47, v139, v124
    v_fmac_f32 v60, v140, v124
    v_fmac_f32 v61, v141, v124
    v_fmac_f32 v62, v142, v124
    v_fmac_f32 v63, v143, v124
    v_mul_f32 v156, v44, v126
    v_mul_f32 v157, v45, v126
    v_mul_f32 v158, v46, v126
    v_mul_f32 v159, v47, v126
    v_mul_f32 v160, v60, v126
    v_mul_f32 v161, v61, v126
    v_mul_f32 v162, v62, v126
    v_mul_f32 v163, v63, v126
    v_exp_f32 v156, v156
    v_exp_f32 v157, v157
    v_exp_f32 v158, v158
    v_exp_f32 v159, v159
    v_exp_f32 v160, v160
    v_exp_f32 v161, v161
    v_exp_f32 v162, v162
    v_exp_f32 v163, v163
    v_fma_f32 v156, v156, v125, v125
    v_fma_f32 v157, v157, v125, v125
    v_fma_f32 v158, v158, v125, v125
    v_fma_f32 v159, v159, v125, v125
    v_fma_f32 v160, v160, v125, v125
    v_fma_f32 v161, v161, v125, v125
    v_fma_f32 v162, v162, v125, v125
    v_fma_f32 v163, v163, v125, v125
    v_rcp_f32 v156, v156
    v_rcp_f32 v157, v157
    v_rcp_f32 v158, v158
    v_rcp_f32 v159, v159
    v_rcp_f32 v160, v160
    v_rcp_f32 v161, v161
    v_rcp_f32 v162, v162
    v_rcp_f32 v163, v163
    v_mul_f32 v156, v156, v44
    v_mul_f32 v157, v157, v45
    v_mul_f32 v158, v158, v46
    v_mul_f32 v159, v159, v47
    v_mul_f32 v160, v160, v60
    v_mul_f32 v161, v161, v61
    v_mul_f32 v162, v162, v62
    v_mul_f32 v163, v163, v63
    v_cvt_pk_bf16_f32 v184, v156, v157
    v_cvt_pk_bf16_f32 v185, v158, v159
    v_cvt_pk_bf16_f32 v186, v160, v161
    v_cvt_pk_bf16_f32 v187, v162, v163
    buffer_store_dwordx4 v[184:187], v207, s[8:11], s25 offen offset:3072 sc1
    ds_write_b128 v212, v[184:187] offset:52224
    v_fmac_f32 v64, v144, v112
    v_fmac_f32 v65, v145, v112
    v_fmac_f32 v66, v146, v112
    v_fmac_f32 v67, v147, v112
    v_fmac_f32 v80, v148, v112
    v_fmac_f32 v81, v149, v112
    v_fmac_f32 v82, v150, v112
    v_fmac_f32 v83, v151, v112
    v_mul_f32 v156, v64, v114
    v_mul_f32 v157, v65, v114
    v_mul_f32 v158, v66, v114
    v_mul_f32 v159, v67, v114
    v_mul_f32 v160, v80, v114
    v_mul_f32 v161, v81, v114
    v_mul_f32 v162, v82, v114
    v_mul_f32 v163, v83, v114
    v_exp_f32 v156, v156
    v_exp_f32 v157, v157
    v_exp_f32 v158, v158
    v_exp_f32 v159, v159
    v_exp_f32 v160, v160
    v_exp_f32 v161, v161
    v_exp_f32 v162, v162
    v_exp_f32 v163, v163
    v_fma_f32 v156, v156, v113, v113
    v_fma_f32 v157, v157, v113, v113
    v_fma_f32 v158, v158, v113, v113
    v_fma_f32 v159, v159, v113, v113
    v_fma_f32 v160, v160, v113, v113
    v_fma_f32 v161, v161, v113, v113
    v_fma_f32 v162, v162, v113, v113
    v_fma_f32 v163, v163, v113, v113
    v_rcp_f32 v156, v156
    v_rcp_f32 v157, v157
    v_rcp_f32 v158, v158
    v_rcp_f32 v159, v159
    v_rcp_f32 v160, v160
    v_rcp_f32 v161, v161
    v_rcp_f32 v162, v162
    v_rcp_f32 v163, v163
    v_mul_f32 v156, v156, v64
    v_mul_f32 v157, v157, v65
    v_mul_f32 v158, v158, v66
    v_mul_f32 v159, v159, v67
    v_mul_f32 v160, v160, v80
    v_mul_f32 v161, v161, v81
    v_mul_f32 v162, v162, v82
    v_mul_f32 v163, v163, v83
    v_cvt_pk_bf16_f32 v172, v156, v157
    v_cvt_pk_bf16_f32 v173, v158, v159
    v_cvt_pk_bf16_f32 v174, v160, v161
    v_cvt_pk_bf16_f32 v175, v162, v163
    buffer_store_dwordx4 v[172:175], v207, s[8:11], s26 offen offset:0 sc1
    v_fmac_f32 v68, v144, v116
    v_fmac_f32 v69, v145, v116
    v_fmac_f32 v70, v146, v116
    v_fmac_f32 v71, v147, v116
    v_fmac_f32 v84, v148, v116
    v_fmac_f32 v85, v149, v116
    v_fmac_f32 v86, v150, v116
    v_fmac_f32 v87, v151, v116
    v_mul_f32 v156, v68, v118
    v_mul_f32 v157, v69, v118
    v_mul_f32 v158, v70, v118
    v_mul_f32 v159, v71, v118
    v_mul_f32 v160, v84, v118
    v_mul_f32 v161, v85, v118
    v_mul_f32 v162, v86, v118
    v_mul_f32 v163, v87, v118
    v_exp_f32 v156, v156
    v_exp_f32 v157, v157
    v_exp_f32 v158, v158
    v_exp_f32 v159, v159
    v_exp_f32 v160, v160
    v_exp_f32 v161, v161
    v_exp_f32 v162, v162
    v_exp_f32 v163, v163
    v_fma_f32 v156, v156, v117, v117
    v_fma_f32 v157, v157, v117, v117
    v_fma_f32 v158, v158, v117, v117
    v_fma_f32 v159, v159, v117, v117
    v_fma_f32 v160, v160, v117, v117
    v_fma_f32 v161, v161, v117, v117
    v_fma_f32 v162, v162, v117, v117
    v_fma_f32 v163, v163, v117, v117
    v_rcp_f32 v156, v156
    v_rcp_f32 v157, v157
    v_rcp_f32 v158, v158
    v_rcp_f32 v159, v159
    v_rcp_f32 v160, v160
    v_rcp_f32 v161, v161
    v_rcp_f32 v162, v162
    v_rcp_f32 v163, v163
    v_mul_f32 v156, v156, v68
    v_mul_f32 v157, v157, v69
    v_mul_f32 v158, v158, v70
    v_mul_f32 v159, v159, v71
    v_mul_f32 v160, v160, v84
    v_mul_f32 v161, v161, v85
    v_mul_f32 v162, v162, v86
    v_mul_f32 v163, v163, v87
    v_cvt_pk_bf16_f32 v176, v156, v157
    v_cvt_pk_bf16_f32 v177, v158, v159
    v_cvt_pk_bf16_f32 v178, v160, v161
    v_cvt_pk_bf16_f32 v179, v162, v163
    buffer_store_dwordx4 v[176:179], v207, s[8:11], s26 offen offset:1024 sc1
    v_fmac_f32 v72, v144, v120
    v_fmac_f32 v73, v145, v120
    v_fmac_f32 v74, v146, v120
    v_fmac_f32 v75, v147, v120
    v_fmac_f32 v88, v148, v120
    v_fmac_f32 v89, v149, v120
    v_fmac_f32 v90, v150, v120
    v_fmac_f32 v91, v151, v120
    v_mul_f32 v156, v72, v122
    v_mul_f32 v157, v73, v122
    v_mul_f32 v158, v74, v122
    v_mul_f32 v159, v75, v122
    v_mul_f32 v160, v88, v122
    v_mul_f32 v161, v89, v122
    v_mul_f32 v162, v90, v122
    v_mul_f32 v163, v91, v122
    v_exp_f32 v156, v156
    v_exp_f32 v157, v157
    v_exp_f32 v158, v158
    v_exp_f32 v159, v159
    v_exp_f32 v160, v160
    v_exp_f32 v161, v161
    v_exp_f32 v162, v162
    v_exp_f32 v163, v163
    v_fma_f32 v156, v156, v121, v121
    v_fma_f32 v157, v157, v121, v121
    v_fma_f32 v158, v158, v121, v121
    v_fma_f32 v159, v159, v121, v121
    v_fma_f32 v160, v160, v121, v121
    v_fma_f32 v161, v161, v121, v121
    v_fma_f32 v162, v162, v121, v121
    v_fma_f32 v163, v163, v121, v121
    v_rcp_f32 v156, v156
    v_rcp_f32 v157, v157
    v_rcp_f32 v158, v158
    v_rcp_f32 v159, v159
    v_rcp_f32 v160, v160
    v_rcp_f32 v161, v161
    v_rcp_f32 v162, v162
    v_rcp_f32 v163, v163
    v_mul_f32 v156, v156, v72
    v_mul_f32 v157, v157, v73
    v_mul_f32 v158, v158, v74
    v_mul_f32 v159, v159, v75
    v_mul_f32 v160, v160, v88
    v_mul_f32 v161, v161, v89
    v_mul_f32 v162, v162, v90
    v_mul_f32 v163, v163, v91
    v_cvt_pk_bf16_f32 v180, v156, v157
    v_cvt_pk_bf16_f32 v181, v158, v159
    v_cvt_pk_bf16_f32 v182, v160, v161
    v_cvt_pk_bf16_f32 v183, v162, v163
    buffer_store_dwordx4 v[180:183], v207, s[8:11], s26 offen offset:2048 sc1
    v_fmac_f32 v76, v144, v124
    v_fmac_f32 v77, v145, v124
    v_fmac_f32 v78, v146, v124
    v_fmac_f32 v79, v147, v124
    v_fmac_f32 v92, v148, v124
    v_fmac_f32 v93, v149, v124
    v_fmac_f32 v94, v150, v124
    v_fmac_f32 v95, v151, v124
    v_mul_f32 v156, v76, v126
    v_mul_f32 v157, v77, v126
    v_mul_f32 v158, v78, v126
    v_mul_f32 v159, v79, v126
    v_mul_f32 v160, v92, v126
    v_mul_f32 v161, v93, v126
    v_mul_f32 v162, v94, v126
    v_mul_f32 v163, v95, v126
    v_exp_f32 v156, v156
    v_exp_f32 v157, v157
    v_exp_f32 v158, v158
    v_exp_f32 v159, v159
    v_exp_f32 v160, v160
    v_exp_f32 v161, v161
    v_exp_f32 v162, v162
    v_exp_f32 v163, v163
    v_fma_f32 v156, v156, v125, v125
    v_fma_f32 v157, v157, v125, v125
    v_fma_f32 v158, v158, v125, v125
    v_fma_f32 v159, v159, v125, v125
    v_fma_f32 v160, v160, v125, v125
    v_fma_f32 v161, v161, v125, v125
    v_fma_f32 v162, v162, v125, v125
    v_fma_f32 v163, v163, v125, v125
    v_rcp_f32 v156, v156
    v_rcp_f32 v157, v157
    v_rcp_f32 v158, v158
    v_rcp_f32 v159, v159
    v_rcp_f32 v160, v160
    v_rcp_f32 v161, v161
    v_rcp_f32 v162, v162
    v_rcp_f32 v163, v163
    v_mul_f32 v156, v156, v76
    v_mul_f32 v157, v157, v77
    v_mul_f32 v158, v158, v78
    v_mul_f32 v159, v159, v79
    v_mul_f32 v160, v160, v92
    v_mul_f32 v161, v161, v93
    v_mul_f32 v162, v162, v94
    v_mul_f32 v163, v163, v95
    v_cvt_pk_bf16_f32 v184, v156, v157
    v_cvt_pk_bf16_f32 v185, v158, v159
    v_cvt_pk_bf16_f32 v186, v160, v161
    v_cvt_pk_bf16_f32 v187, v162, v163
    buffer_store_dwordx4 v[184:187], v207, s[8:11], s26 offen offset:3072 sc1
    v_fmac_f32 v96, v152, v112
    v_fmac_f32 v97, v153, v112
    v_fmac_f32 v98, v154, v112
    v_fmac_f32 v99, v155, v112
    v_fmac_f32 v100, v152, v116
    v_fmac_f32 v101, v153, v116
    v_fmac_f32 v102, v154, v116
    v_fmac_f32 v103, v155, v116
    v_mul_f32 v156, v96, v114
    v_mul_f32 v157, v97, v114
    v_mul_f32 v158, v98, v114
    v_mul_f32 v159, v99, v114
    v_mul_f32 v160, v100, v118
    v_mul_f32 v161, v101, v118
    v_mul_f32 v162, v102, v118
    v_mul_f32 v163, v103, v118
    v_exp_f32 v156, v156
    v_exp_f32 v157, v157
    v_exp_f32 v158, v158
    v_exp_f32 v159, v159
    v_exp_f32 v160, v160
    v_exp_f32 v161, v161
    v_exp_f32 v162, v162
    v_exp_f32 v163, v163
    v_fma_f32 v156, v156, v113, v113
    v_fma_f32 v157, v157, v113, v113
    v_fma_f32 v158, v158, v113, v113
    v_fma_f32 v159, v159, v113, v113
    v_fma_f32 v160, v160, v117, v117
    v_fma_f32 v161, v161, v117, v117
    v_fma_f32 v162, v162, v117, v117
    v_fma_f32 v163, v163, v117, v117
    v_rcp_f32 v156, v156
    v_rcp_f32 v157, v157
    v_rcp_f32 v158, v158
    v_rcp_f32 v159, v159
    v_rcp_f32 v160, v160
    v_rcp_f32 v161, v161
    v_rcp_f32 v162, v162
    v_rcp_f32 v163, v163
    v_mul_f32 v156, v156, v96
    v_mul_f32 v157, v157, v97
    v_mul_f32 v158, v158, v98
    v_mul_f32 v159, v159, v99
    v_mul_f32 v160, v160, v100
    v_mul_f32 v161, v161, v101
    v_mul_f32 v162, v162, v102
    v_mul_f32 v163, v163, v103
    v_cvt_pk_bf16_f32 v172, v156, v157
    v_cvt_pk_bf16_f32 v173, v158, v159
    v_cvt_pk_bf16_f32 v174, v160, v161
    v_cvt_pk_bf16_f32 v175, v162, v163
    buffer_store_dwordx4 v[172:175], v207, s[8:11], s27 offen offset:0 sc1
    v_fmac_f32 v104, v152, v120
    v_fmac_f32 v105, v153, v120
    v_fmac_f32 v106, v154, v120
    v_fmac_f32 v107, v155, v120
    v_fmac_f32 v108, v152, v124
    v_fmac_f32 v109, v153, v124
    v_fmac_f32 v110, v154, v124
    v_fmac_f32 v111, v155, v124
    v_mul_f32 v156, v104, v122
    v_mul_f32 v157, v105, v122
    v_mul_f32 v158, v106, v122
    v_mul_f32 v159, v107, v122
    v_mul_f32 v160, v108, v126
    v_mul_f32 v161, v109, v126
    v_mul_f32 v162, v110, v126
    v_mul_f32 v163, v111, v126
    v_exp_f32 v156, v156
    v_exp_f32 v157, v157
    v_exp_f32 v158, v158
    v_exp_f32 v159, v159
    v_exp_f32 v160, v160
    v_exp_f32 v161, v161
    v_exp_f32 v162, v162
    v_exp_f32 v163, v163
    v_fma_f32 v156, v156, v121, v121
    v_fma_f32 v157, v157, v121, v121
    v_fma_f32 v158, v158, v121, v121
    v_fma_f32 v159, v159, v121, v121
    v_fma_f32 v160, v160, v125, v125
    v_fma_f32 v161, v161, v125, v125
    v_fma_f32 v162, v162, v125, v125
    v_fma_f32 v163, v163, v125, v125
    v_rcp_f32 v156, v156
    v_rcp_f32 v157, v157
    v_rcp_f32 v158, v158
    v_rcp_f32 v159, v159
    v_rcp_f32 v160, v160
    v_rcp_f32 v161, v161
    v_rcp_f32 v162, v162
    v_rcp_f32 v163, v163
    v_mul_f32 v156, v156, v104
    v_mul_f32 v157, v157, v105
    v_mul_f32 v158, v158, v106
    v_mul_f32 v159, v159, v107
    v_mul_f32 v160, v160, v108
    v_mul_f32 v161, v161, v109
    v_mul_f32 v162, v162, v110
    v_mul_f32 v163, v163, v111
    v_cvt_pk_bf16_f32 v176, v156, v157
    v_cvt_pk_bf16_f32 v177, v158, v159
    v_cvt_pk_bf16_f32 v178, v160, v161
    v_cvt_pk_bf16_f32 v179, v162, v163
    buffer_store_dwordx4 v[176:179], v207, s[8:11], s27 offen offset:2048 sc1
    s_cmp_lg_u32 s3, 0
    s_cbranch_scc1 L_nopoll0
    buffer_load_dwordx2 v[208:209], v254, s[28:31], s82 offen sc1
L_nopoll0:
    v_bfe_u32 v196, v205, 3, 2
    v_lshlrev_b32 v196, 5, v196
    v_xor_b32 v196, s64, v196
    v_lshl_add_u32 v196, v246, 7, v196
    v_add_u32 v192, v196, v247
    v_xor_b32 v193, 32, v192
    v_add_u32 v194, 79872, v192
    v_add_u32 v195, 79872, v193
    v_add_u32 v197, s85, v207
    v_mul_u32_u24 v198, 144, v213
    v_add3_u32 v198, v198, v250, s32
    v_lshlrev_b32 v247, 1, v247
    v_lshl_add_u32 v196, v246, 7, v247
    v_add_u32 v196, s83, v196
    v_lshrrev_b32 v245, 3, v205
    v_and_b32 v247, 7, v205
    v_lshlrev_b32 v247, 4, v247
    v_mul_u32_u24 v199, 144, v245
    v_add3_u32 v199, v199, v247, s33
    v_lshl_add_u32 v245, v245, 11, v247
    s_waitcnt vmcnt(0)
    v_mov_b32 v248, s94
    v_mov_b32 v249, s95
    s_mov_b64 exec, 1
    buffer_store_dwordx2 v[248:249], off, s[28:31], s80 sc1
    s_mov_b64 exec, -1
    s_cmp_lg_u32 s3, 0
    s_cbranch_scc1 L_nopoll
    v_cmp_ne_u64 vcc, s[94:95], v[208:209]
    s_and_b64 vcc, vcc, s[72:73]
    s_cbranch_vccz L_rpok_18
    s_mov_b32 s62, 200000
L_rp_17:
    s_sleep 2
    buffer_load_dwordx2 v[208:209], v254, s[28:31], s82 offen sc1
    s_waitcnt vmcnt(0)
    v_cmp_ne_u64 vcc, s[94:95], v[208:209]
    s_and_b64 vcc, vcc, s[72:73]
    s_cbranch_vccz L_rpok_18
    s_sub_u32 s62, s62, 1
    s_cmp_lg_u32 s62, 0
    s_cbranch_scc1 L_rp_17
L_rpok_18:
L_nopoll:
    s_waitcnt lgkmcnt(0)
    s_barrier
    ds_read_b64_tr_b16 v[64:65], v200 offset:0
    ds_read_b64_tr_b16 v[66:67], v200 offset:4096
    ds_read_b128 v[80:83], v204 offset:0
    ds_read_b128 v[84:87], v204 offset:1024
    ds_read_b128 v[88:91], v204 offset:2048
    ds_read_b128 v[92:95], v204 offset:3072
    ds_read_b64_tr_b16 v[68:69], v201 offset:0
    ds_read_b64_tr_b16 v[70:71], v201 offset:4096
    ds_read_b64_tr_b16 v[72:73], v202 offset:0
    ds_read_b64_tr_b16 v[74:75], v202 offset:4096
    ds_read_b64_tr_b16 v[76:77], v203 offset:0
    ds_read_b64_tr_b16 v[78:79], v203 offset:4096
    s_mov_b32 s75, 0
    s_waitcnt lgkmcnt(6)
    v_mfma_f32_16x16x32_bf16 v[0:3], v[64:67], v[80:83], 0
    ds_read_b64_tr_b16 v[96:97], v200 offset:8192
    v_mfma_f32_16x16x32_bf16 v[4:7], v[64:67], v[84:87], 0
    ds_read_b64_tr_b16 v[98:99], v200 offset:12288
    v_mfma_f32_16x16x32_bf16 v[8:11], v[64:67], v[88:91], 0
    ds_read_b128 v[112:115], v204 offset:8192
    v_mfma_f32_16x16x32_bf16 v[12:15], v[64:67], v[92:95], 0
    ds_read_b128 v[116:119], v204 offset:9216
    s_waitcnt lgkmcnt(8)
    v_mfma_f32_16x16x32_bf16 v[28:31], v[68:71], v[92:95], 0
    ds_read_b128 v[120:123], v204 offset:10240
    v_mfma_f32_16x16x32_bf16 v[24:27], v[68:71], v[88:91], 0
    ds_read_b128 v[124:127], v204 offset:11264
    v_mfma_f32_16x16x32_bf16 v[20:23], v[68:71], v[84:87], 0
    ds_read_b64_tr_b16 v[100:101], v201 offset:8192
    v_mfma_f32_16x16x32_bf16 v[16:19], v[68:71], v[80:83], 0
    ds_read_b64_tr_b16 v[102:103], v201 offset:12288
    s_waitcnt lgkmcnt(10)
    v_mfma_f32_16x16x32_bf16 v[32:35], v[72:75], v[80:83], 0
    ds_read_b64_tr_b16 v[104:105], v202 offset:8192
    v_mfma_f32_16x16x32_bf16 v[36:39], v[72:75], v[84:87], 0
    ds_read_b64_tr_b16 v[106:107], v202 offset:12288
    v_mfma_f32_16x16x32_bf16 v[40:43], v[72:75], v[88:91], 0
    ds_read_b64_tr_b16 v[108:109], v203 offset:8192
    v_mfma_f32_16x16x32_bf16 v[44:47], v[72:75], v[92:95], 0
    ds_read_b64_tr_b16 v[110:111], v203 offset:12288
    s_waitcnt lgkmcnt(12)
    v_mfma_f32_16x16x32_bf16 v[60:63], v[76:79], v[92:95], 0
    v_mfma_f32_16x16x32_bf16 v[56:59], v[76:79], v[88:91], 0
    v_mfma_f32_16x16x32_bf16 v[52:55], v[76:79], v[84:87], 0
    v_mfma_f32_16x16x32_bf16 v[48:51], v[76:79], v[80:83], 0
    s_branch L_g1_in
    .p2align 3
L_g1_loop:
    s_waitcnt lgkmcnt(6)
    v_mfma_f32_16x16x32_bf16 v[0:3], v[64:67], v[80:83], v[0:3]
    ds_read_b64_tr_b16 v[96:97], v200 offset:8192
    v_mfma_f32_16x16x32_bf16 v[4:7], v[64:67], v[84:87], v[4:7]
    ds_read_b64_tr_b16 v[98:99], v200 offset:12288
    v_mfma_f32_16x16x32_bf16 v[8:11], v[64:67], v[88:91], v[8:11]
    ds_read_b128 v[112:115], v204 offset:8192
    v_mfma_f32_16x16x32_bf16 v[12:15], v[64:67], v[92:95], v[12:15]
    ds_read_b128 v[116:119], v204 offset:9216
    s_waitcnt lgkmcnt(8)
    v_mfma_f32_16x16x32_bf16 v[28:31], v[68:71], v[92:95], v[28:31]
    ds_read_b128 v[120:123], v204 offset:10240
    v_mfma_f32_16x16x32_bf16 v[24:27], v[68:71], v[88:91], v[24:27]
    ds_read_b128 v[124:127], v204 offset:11264
    v_mfma_f32_16x16x32_bf16 v[20:23], v[68:71], v[84:87], v[20:23]
    ds_read_b64_tr_b16 v[100:101], v201 offset:8192
    v_mfma_f32_16x16x32_bf16 v[16:19], v[68:71], v[80:83], v[16:19]
    ds_read_b64_tr_b16 v[102:103], v201 offset:12288
    s_waitcnt lgkmcnt(10)
    v_mfma_f32_16x16x32_bf16 v[32:35], v[72:75], v[80:83], v[32:35]
    ds_read_b64_tr_b16 v[104:105], v202 offset:8192
    v_mfma_f32_16x16x32_bf16 v[36:39], v[72:75], v[84:87], v[36:39]
    ds_read_b64_tr_b16 v[106:107], v202 offset:12288
    v_mfma_f32_16x16x32_bf16 v[40:43], v[72:75], v[88:91], v[40:43]
    ds_read_b64_tr_b16 v[108:109], v203 offset:8192
    v_mfma_f32_16x16x32_bf16 v[44:47], v[72:75], v[92:95], v[44:47]
    ds_read_b64_tr_b16 v[110:111], v203 offset:12288
    s_waitcnt lgkmcnt(12)
    v_mfma_f32_16x16x32_bf16 v[60:63], v[76:79], v[92:95], v[60:63]
    v_mfma_f32_16x16x32_bf16 v[56:59], v[76:79], v[88:91], v[56:59]
    v_mfma_f32_16x16x32_bf16 v[52:55], v[76:79], v[84:87], v[52:55]
    v_mfma_f32_16x16x32_bf16 v[48:51], v[76:79], v[80:83], v[48:51]
L_g1_in:
    s_barrier
    s_waitcnt lgkmcnt(6)
    v_mfma_f32_16x16x32_bf16 v[0:3], v[96:99], v[112:115], v[0:3]
    ds_read_b64_tr_b16 v[64:65], v200 offset:32768
    v_mfma_f32_16x16x32_bf16 v[4:7], v[96:99], v[116:119], v[4:7]
    ds_read_b64_tr_b16 v[66:67], v200 offset:36864
    v_mfma_f32_16x16x32_bf16 v[8:11], v[96:99], v[120:123], v[8:11]
    ds_read_b128 v[80:83], v204 offset:32768
    v_mfma_f32_16x16x32_bf16 v[12:15], v[96:99], v[124:127], v[12:15]
    ds_read_b128 v[84:87], v204 offset:33792
    s_waitcnt lgkmcnt(8)
    v_mfma_f32_16x16x32_bf16 v[28:31], v[100:103], v[124:127], v[28:31]
    ds_read_b128 v[88:91], v204 offset:34816
    v_mfma_f32_16x16x32_bf16 v[24:27], v[100:103], v[120:123], v[24:27]
    ds_read_b128 v[92:95], v204 offset:35840
    v_mfma_f32_16x16x32_bf16 v[20:23], v[100:103], v[116:119], v[20:23]
    ds_read_b64_tr_b16 v[68:69], v201 offset:32768
    v_mfma_f32_16x16x32_bf16 v[16:19], v[100:103], v[112:115], v[16:19]
    ds_read_b64_tr_b16 v[70:71], v201 offset:36864
    s_waitcnt lgkmcnt(10)
    v_mfma_f32_16x16x32_bf16 v[32:35], v[104:107], v[112:115], v[32:35]
    ds_read_b64_tr_b16 v[72:73], v202 offset:32768
    v_mfma_f32_16x16x32_bf16 v[36:39], v[104:107], v[116:119], v[36:39]
    ds_read_b64_tr_b16 v[74:75], v202 offset:36864
    v_mfma_f32_16x16x32_bf16 v[40:43], v[104:107], v[120:123], v[40:43]
    ds_read_b64_tr_b16 v[76:77], v203 offset:32768
    v_mfma_f32_16x16x32_bf16 v[44:47], v[104:107], v[124:127], v[44:47]
    ds_read_b64_tr_b16 v[78:79], v203 offset:36864
    s_waitcnt lgkmcnt(12)
    v_mfma_f32_16x16x32_bf16 v[60:63], v[108:111], v[124:127], v[60:63]
    v_mfma_f32_16x16x32_bf16 v[56:59], v[108:111], v[120:123], v[56:59]
    v_mfma_f32_16x16x32_bf16 v[52:55], v[108:111], v[116:119], v[52:55]
    v_mfma_f32_16x16x32_bf16 v[48:51], v[108:111], v[112:115], v[48:51]
    s_waitcnt lgkmcnt(6)
    v_mfma_f32_16x16x32_bf16 v[0:3], v[64:67], v[80:83], v[0:3]
    ds_read_b64_tr_b16 v[96:97], v200 offset:40960
    v_mfma_f32_16x16x32_bf16 v[4:7], v[64:67], v[84:87], v[4:7]
    ds_read_b64_tr_b16 v[98:99], v200 offset:45056
    v_mfma_f32_16x16x32_bf16 v[8:11], v[64:67], v[88:91], v[8:11]
    ds_read_b128 v[112:115], v204 offset:40960
    v_mfma_f32_16x16x32_bf16 v[12:15], v[64:67], v[92:95], v[12:15]
    ds_read_b128 v[116:119], v204 offset:41984
    s_waitcnt lgkmcnt(8)
    v_mfma_f32_16x16x32_bf16 v[28:31], v[68:71], v[92:95], v[28:31]
    ds_read_b128 v[120:123], v204 offset:43008
    v_mfma_f32_16x16x32_bf16 v[24:27], v[68:71], v[88:91], v[24:27]
    ds_read_b128 v[124:127], v204 offset:44032
    v_mfma_f32_16x16x32_bf16 v[20:23], v[68:71], v[84:87], v[20:23]
    ds_read_b64_tr_b16 v[100:101], v201 offset:40960
    v_mfma_f32_16x16x32_bf16 v[16:19], v[68:71], v[80:83], v[16:19]
    ds_read_b64_tr_b16 v[102:103], v201 offset:45056
    s_waitcnt lgkmcnt(10)
    v_mfma_f32_16x16x32_bf16 v[32:35], v[72:75], v[80:83], v[32:35]
    ds_read_b64_tr_b16 v[104:105], v202 offset:40960
    v_mfma_f32_16x16x32_bf16 v[36:39], v[72:75], v[84:87], v[36:39]
    ds_read_b64_tr_b16 v[106:107], v202 offset:45056
    v_mfma_f32_16x16x32_bf16 v[40:43], v[72:75], v[88:91], v[40:43]
    ds_read_b64_tr_b16 v[108:109], v203 offset:40960
    v_mfma_f32_16x16x32_bf16 v[44:47], v[72:75], v[92:95], v[44:47]
    ds_read_b64_tr_b16 v[110:111], v203 offset:45056
    s_waitcnt lgkmcnt(12)
    v_mfma_f32_16x16x32_bf16 v[60:63], v[76:79], v[92:95], v[60:63]
    v_mfma_f32_16x16x32_bf16 v[56:59], v[76:79], v[88:91], v[56:59]
    v_mfma_f32_16x16x32_bf16 v[52:55], v[76:79], v[84:87], v[52:55]
    v_mfma_f32_16x16x32_bf16 v[48:51], v[76:79], v[80:83], v[48:51]
    s_barrier
    s_waitcnt lgkmcnt(6)
    v_mfma_f32_16x16x32_bf16 v[0:3], v[96:99], v[112:115], v[0:3]
    ds_read_b64_tr_b16 v[64:65], v240 offset:0
    v_mfma_f32_16x16x32_bf16 v[4:7], v[96:99], v[116:119], v[4:7]
    ds_read_b64_tr_b16 v[66:67], v240 offset:4096
    v_mfma_f32_16x16x32_bf16 v[8:11], v[96:99], v[120:123], v[8:11]
    ds_read_b128 v[80:83], v244 offset:0
    v_mfma_f32_16x16x32_bf16 v[12:15], v[96:99], v[124:127], v[12:15]
    ds_read_b128 v[84:87], v244 offset:1024
    s_waitcnt lgkmcnt(8)
    v_mfma_f32_16x16x32_bf16 v[28:31], v[100:103], v[124:127], v[28:31]
    ds_read_b128 v[88:91], v244 offset:2048
    v_mfma_f32_16x16x32_bf16 v[24:27], v[100:103], v[120:123], v[24:27]
    ds_read_b128 v[92:95], v244 offset:3072
    v_mfma_f32_16x16x32_bf16 v[20:23], v[100:103], v[116:119], v[20:23]
    ds_read_b64_tr_b16 v[68:69], v241 offset:0
    v_mfma_f32_16x16x32_bf16 v[16:19], v[100:103], v[112:115], v[16:19]
    ds_read_b64_tr_b16 v[70:71], v241 offset:4096
    s_waitcnt lgkmcnt(10)
    v_mfma_f32_16x16x32_bf16 v[32:35], v[104:107], v[112:115], v[32:35]
    ds_read_b64_tr_b16 v[72:73], v242 offset:0
    v_mfma_f32_16x16x32_bf16 v[36:39], v[104:107], v[116:119], v[36:39]
    ds_read_b64_tr_b16 v[74:75], v242 offset:4096
    v_mfma_f32_16x16x32_bf16 v[40:43], v[104:107], v[120:123], v[40:43]
    ds_read_b64_tr_b16 v[76:77], v243 offset:0
    v_mfma_f32_16x16x32_bf16 v[44:47], v[104:107], v[124:127], v[44:47]
    ds_read_b64_tr_b16 v[78:79], v243 offset:4096
    s_waitcnt lgkmcnt(12)
    v_mfma_f32_16x16x32_bf16 v[60:63], v[108:111], v[124:127], v[60:63]
    v_mfma_f32_16x16x32_bf16 v[56:59], v[108:111], v[120:123], v[56:59]
    v_mfma_f32_16x16x32_bf16 v[52:55], v[108:111], v[116:119], v[52:55]
    v_mfma_f32_16x16x32_bf16 v[48:51], v[108:111], v[112:115], v[48:51]
    s_waitcnt lgkmcnt(6)
    v_mfma_f32_16x16x32_bf16 v[0:3], v[64:67], v[80:83], v[0:3]
    ds_read_b64_tr_b16 v[96:97], v240 offset:8192
    v_mfma_f32_16x16x32_bf16 v[4:7], v[64:67], v[84:87], v[4:7]
    ds_read_b64_tr_b16 v[98:99], v240 offset:12288
    v_mfma_f32_16x16x32_bf16 v[8:11], v[64:67], v[88:91], v[8:11]
    ds_read_b128 v[112:115], v244 offset:8192
    v_mfma_f32_16x16x32_bf16 v[12:15], v[64:67], v[92:95], v[12:15]
    ds_read_b128 v[116:119], v244 offset:9216
    s_waitcnt lgkmcnt(8)
    v_mfma_f32_16x16x32_bf16 v[28:31], v[68:71], v[92:95], v[28:31]
    ds_read_b128 v[120:123], v244 offset:10240
    v_mfma_f32_16x16x32_bf16 v[24:27], v[68:71], v[88:91], v[24:27]
    ds_read_b128 v[124:127], v244 offset:11264
    v_mfma_f32_16x16x32_bf16 v[20:23], v[68:71], v[84:87], v[20:23]
    ds_read_b64_tr_b16 v[100:101], v241 offset:8192
    v_mfma_f32_16x16x32_bf16 v[16:19], v[68:71], v[80:83], v[16:19]
    ds_read_b64_tr_b16 v[102:103], v241 offset:12288
    s_waitcnt lgkmcnt(10)
    v_mfma_f32_16x16x32_bf16 v[32:35], v[72:75], v[80:83], v[32:35]
    ds_read_b64_tr_b16 v[104:105], v242 offset:8192
    v_mfma_f32_16x16x32_bf16 v[36:39], v[72:75], v[84:87], v[36:39]
    ds_read_b64_tr_b16 v[106:107], v242 offset:12288
    v_mfma_f32_16x16x32_bf16 v[40:43], v[72:75], v[88:91], v[40:43]
    ds_read_b64_tr_b16 v[108:109], v243 offset:8192
    v_mfma_f32_16x16x32_bf16 v[44:47], v[72:75], v[92:95], v[44:47]
    ds_read_b64_tr_b16 v[110:111], v243 offset:12288
    s_waitcnt lgkmcnt(12)
    v_mfma_f32_16x16x32_bf16 v[60:63], v[76:79], v[92:95], v[60:63]
    v_mfma_f32_16x16x32_bf16 v[56:59], v[76:79], v[88:91], v[56:59]
    v_mfma_f32_16x16x32_bf16 v[52:55], v[76:79], v[84:87], v[52:55]
    v_mfma_f32_16x16x32_bf16 v[48:51], v[76:79], v[80:83], v[48:51]
    s_barrier
    s_waitcnt lgkmcnt(6)
    v_mfma_f32_16x16x32_bf16 v[0:3], v[96:99], v[112:115], v[0:3]
    ds_read_b64_tr_b16 v[64:65], v240 offset:32768
    v_mfma_f32_16x16x32_bf16 v[4:7], v[96:99], v[116:119], v[4:7]
    ds_read_b64_tr_b16 v[66:67], v240 offset:36864
    v_mfma_f32_16x16x32_bf16 v[8:11], v[96:99], v[120:123], v[8:11]
    ds_read_b128 v[80:83], v244 offset:32768
    v_mfma_f32_16x16x32_bf16 v[12:15], v[96:99], v[124:127], v[12:15]
    ds_read_b128 v[84:87], v244 offset:33792
    s_waitcnt lgkmcnt(8)
    v_mfma_f32_16x16x32_bf16 v[28:31], v[100:103], v[124:127], v[28:31]
    ds_read_b128 v[88:91], v244 offset:34816
    v_mfma_f32_16x16x32_bf16 v[24:27], v[100:103], v[120:123], v[24:27]
    ds_read_b128 v[92:95], v244 offset:35840
    v_mfma_f32_16x16x32_bf16 v[20:23], v[100:103], v[116:119], v[20:23]
    ds_read_b64_tr_b16 v[68:69], v241 offset:32768
    v_mfma_f32_16x16x32_bf16 v[16:19], v[100:103], v[112:115], v[16:19]
    ds_read_b64_tr_b16 v[70:71], v241 offset:36864
    s_waitcnt lgkmcnt(10)
    v_mfma_f32_16x16x32_bf16 v[32:35], v[104:107], v[112:115], v[32:35]
    ds_read_b64_tr_b16 v[72:73], v242 offset:32768
    v_mfma_f32_16x16x32_bf16 v[36:39], v[104:107], v[116:119], v[36:39]
    ds_read_b64_tr_b16 v[74:75], v242 offset:36864
    v_mfma_f32_16x16x32_bf16 v[40:43], v[104:107], v[120:123], v[40:43]
    ds_read_b64_tr_b16 v[76:77], v243 offset:32768
    v_mfma_f32_16x16x32_bf16 v[44:47], v[104:107], v[124:127], v[44:47]
    ds_read_b64_tr_b16 v[78:79], v243 offset:36864
    s_waitcnt lgkmcnt(12)
    v_mfma_f32_16x16x32_bf16 v[60:63], v[108:111], v[124:127], v[60:63]
    v_mfma_f32_16x16x32_bf16 v[56:59], v[108:111], v[120:123], v[56:59]
    v_mfma_f32_16x16x32_bf16 v[52:55], v[108:111], v[116:119], v[52:55]
    v_mfma_f32_16x16x32_bf16 v[48:51], v[108:111], v[112:115], v[48:51]
    s_waitcnt lgkmcnt(6)
    v_mfma_f32_16x16x32_bf16 v[0:3], v[64:67], v[80:83], v[0:3]
    ds_read_b64_tr_b16 v[96:97], v240 offset:40960
    v_mfma_f32_16x16x32_bf16 v[4:7], v[64:67], v[84:87], v[4:7]
    ds_read_b64_tr_b16 v[98:99], v240 offset:45056
    v_mfma_f32_16x16x32_bf16 v[8:11], v[64:67], v[88:91], v[8:11]
    ds_read_b128 v[112:115], v244 offset:40960
    v_mfma_f32_16x16x32_bf16 v[12:15], v[64:67], v[92:95], v[12:15]
    ds_read_b128 v[116:119], v244 offset:41984
    s_waitcnt lgkmcnt(8)
    v_mfma_f32_16x16x32_bf16 v[28:31], v[68:71], v[92:95], v[28:31]
    ds_read_b128 v[120:123], v244 offset:43008
    v_mfma_f32_16x16x32_bf16 v[24:27], v[68:71], v[88:91], v[24:27]
    ds_read_b128 v[124:127], v244 offset:44032
    v_mfma_f32_16x16x32_bf16 v[20:23], v[68:71], v[84:87], v[20:23]
    ds_read_b64_tr_b16 v[100:101], v241 offset:40960
    v_mfma_f32_16x16x32_bf16 v[16:19], v[68:71], v[80:83], v[16:19]
    ds_read_b64_tr_b16 v[102:103], v241 offset:45056
    s_waitcnt lgkmcnt(10)
    v_mfma_f32_16x16x32_bf16 v[32:35], v[72:75], v[80:83], v[32:35]
    ds_read_b64_tr_b16 v[104:105], v242 offset:40960
    v_mfma_f32_16x16x32_bf16 v[36:39], v[72:75], v[84:87], v[36:39]
    ds_read_b64_tr_b16 v[106:107], v242 offset:45056
    v_mfma_f32_16x16x32_bf16 v[40:43], v[72:75], v[88:91], v[40:43]
    ds_read_b64_tr_b16 v[108:109], v243 offset:40960
    v_mfma_f32_16x16x32_bf16 v[44:47], v[72:75], v[92:95], v[44:47]
    ds_read_b64_tr_b16 v[110:111], v243 offset:45056
    s_waitcnt lgkmcnt(12)
    v_mfma_f32_16x16x32_bf16 v[60:63], v[76:79], v[92:95], v[60:63]
    s_add_u32 s75, s75, 1
    s_cmp_eq_u32 s75, 6
    v_mfma_f32_16x16x32_bf16 v[56:59], v[76:79], v[88:91], v[56:59]
    v_mfma_f32_16x16x32_bf16 v[52:55], v[76:79], v[84:87], v[52:55]
    v_mfma_f32_16x16x32_bf16 v[48:51], v[76:79], v[80:83], v[48:51]
    s_barrier
    s_cbranch_scc1 L_g1_last
    s_waitcnt lgkmcnt(6)
    v_mfma_f32_16x16x32_bf16 v[0:3], v[96:99], v[112:115], v[0:3]
    ds_read_b64_tr_b16 v[64:65], v200 offset:0
    v_mfma_f32_16x16x32_bf16 v[4:7], v[96:99], v[116:119], v[4:7]
    ds_read_b64_tr_b16 v[66:67], v200 offset:4096
    v_mfma_f32_16x16x32_bf16 v[8:11], v[96:99], v[120:123], v[8:11]
    ds_read_b128 v[80:83], v204 offset:0
    v_mfma_f32_16x16x32_bf16 v[12:15], v[96:99], v[124:127], v[12:15]
    ds_read_b128 v[84:87], v204 offset:1024
    s_waitcnt lgkmcnt(8)
    v_mfma_f32_16x16x32_bf16 v[28:31], v[100:103], v[124:127], v[28:31]
    ds_read_b128 v[88:91], v204 offset:2048
    v_mfma_f32_16x16x32_bf16 v[24:27], v[100:103], v[120:123], v[24:27]
    ds_read_b128 v[92:95], v204 offset:3072
    v_mfma_f32_16x16x32_bf16 v[20:23], v[100:103], v[116:119], v[20:23]
    ds_read_b64_tr_b16 v[68:69], v201 offset:0
    v_mfma_f32_16x16x32_bf16 v[16:19], v[100:103], v[112:115], v[16:19]
    ds_read_b64_tr_b16 v[70:71], v201 offset:4096
    s_waitcnt lgkmcnt(10)
    v_mfma_f32_16x16x32_bf16 v[32:35], v[104:107], v[112:115], v[32:35]
    ds_read_b64_tr_b16 v[72:73], v202 offset:0
    v_mfma_f32_16x16x32_bf16 v[36:39], v[104:107], v[116:119], v[36:39]
    ds_read_b64_tr_b16 v[74:75], v202 offset:4096
    v_mfma_f32_16x16x32_bf16 v[40:43], v[104:107], v[120:123], v[40:43]
    ds_read_b64_tr_b16 v[76:77], v203 offset:0
    v_mfma_f32_16x16x32_bf16 v[44:47], v[104:107], v[124:127], v[44:47]
    ds_read_b64_tr_b16 v[78:79], v203 offset:4096
    s_waitcnt lgkmcnt(12)
    v_mfma_f32_16x16x32_bf16 v[60:63], v[108:111], v[124:127], v[60:63]
    v_mfma_f32_16x16x32_bf16 v[56:59], v[108:111], v[120:123], v[56:59]
    v_mfma_f32_16x16x32_bf16 v[52:55], v[108:111], v[116:119], v[52:55]
    v_mfma_f32_16x16x32_bf16 v[48:51], v[108:111], v[112:115], v[48:51]
    s_branch L_g1_loop
L_g1_last:
    s_waitcnt lgkmcnt(6)
    v_mfma_f32_16x16x32_bf16 v[0:3], v[96:99], v[112:115], v[0:3]
    ds_read_b64_tr_b16 v[64:65], v200 offset:0
    v_mfma_f32_16x16x32_bf16 v[4:7], v[96:99], v[116:119], v[4:7]
    ds_read_b64_tr_b16 v[66:67], v200 offset:4096
    v_mfma_f32_16x16x32_bf16 v[8:11], v[96:99], v[120:123], v[8:11]
    ds_read_b128 v[80:83], v204 offset:0
    v_mfma_f32_16x16x32_bf16 v[12:15], v[96:99], v[124:127], v[12:15]
    ds_read_b128 v[84:87], v204 offset:1024
    s_waitcnt lgkmcnt(8)
    v_mfma_f32_16x16x32_bf16 v[28:31], v[100:103], v[124:127], v[28:31]
    ds_read_b128 v[88:91], v204 offset:2048
    v_mfma_f32_16x16x32_bf16 v[24:27], v[100:103], v[120:123], v[24:27]
    ds_read_b128 v[92:95], v204 offset:3072
    v_mfma_f32_16x16x32_bf16 v[20:23], v[100:103], v[116:119], v[20:23]
    ds_read_b64_tr_b16 v[68:69], v201 offset:0
    v_mfma_f32_16x16x32_bf16 v[16:19], v[100:103], v[112:115], v[16:19]
    ds_read_b64_tr_b16 v[70:71], v201 offset:4096
    s_waitcnt lgkmcnt(10)
    v_mfma_f32_16x16x32_bf16 v[32:35], v[104:107], v[112:115], v[32:35]
    ds_read_b64_tr_b16 v[72:73], v202 offset:0
    v_mfma_f32_16x16x32_bf16 v[36:39], v[104:107], v[116:119], v[36:39]
    ds_read_b64_tr_b16 v[74:75], v202 offset:4096
    v_mfma_f32_16x16x32_bf16 v[40:43], v[104:107], v[120:123], v[40:43]
    ds_read_b64_tr_b16 v[76:77], v203 offset:0
    v_mfma_f32_16x16x32_bf16 v[44:47], v[104:107], v[124:127], v[44:47]
    ds_read_b64_tr_b16 v[78:79], v203 offset:4096
    s_waitcnt lgkmcnt(12)
    v_mfma_f32_16x16x32_bf16 v[60:63], v[108:111], v[124:127], v[60:63]
    v_mfma_f32_16x16x32_bf16 v[56:59], v[108:111], v[120:123], v[56:59]
    v_mfma_f32_16x16x32_bf16 v[52:55], v[108:111], v[116:119], v[52:55]
    v_mfma_f32_16x16x32_bf16 v[48:51], v[108:111], v[112:115], v[48:51]
    s_waitcnt lgkmcnt(6)
    v_swap_b32 v82, v84
    v_swap_b32 v83, v85
    v_swap_b32 v90, v92
    v_swap_b32 v91, v93
    s_waitcnt lgkmcnt(6)
    v_mfma_f32_16x16x32_bf16 v[0:3], v[64:67], v[80:83], v[0:3]
    ds_read_b64_tr_b16 v[96:97], v200 offset:8192
    v_lshlrev_b32 v160, 16, v216
    v_and_b32 v161, 0xffff0000, v216
    v_mfma_f32_16x16x32_bf16 v[4:7], v[64:67], v[84:87], v[4:7]
    ds_read_b64_tr_b16 v[98:99], v200 offset:12288
    v_lshlrev_b32 v162, 16, v217
    v_and_b32 v163, 0xffff0000, v217
    v_mfma_f32_16x16x32_bf16 v[8:11], v[64:67], v[88:91], v[8:11]
    ds_read_b128 v[112:115], v204 offset:8192
    v_lshlrev_b32 v164, 16, v218
    v_and_b32 v165, 0xffff0000, v218
    v_mfma_f32_16x16x32_bf16 v[12:15], v[64:67], v[92:95], v[12:15]
    ds_read_b128 v[116:119], v204 offset:9216
    v_lshlrev_b32 v166, 16, v219
    v_and_b32 v167, 0xffff0000, v219
    s_waitcnt lgkmcnt(8)
    v_mfma_f32_16x16x32_bf16 v[28:31], v[68:71], v[92:95], v[28:31]
    ds_read_b128 v[120:123], v204 offset:10240
    v_lshlrev_b32 v168, 16, v220
    v_and_b32 v169, 0xffff0000, v220
    v_mfma_f32_16x16x32_bf16 v[24:27], v[68:71], v[88:91], v[24:27]
    ds_read_b128 v[124:127], v204 offset:11264
    v_lshlrev_b32 v170, 16, v221
    v_and_b32 v171, 0xffff0000, v221
    v_mfma_f32_16x16x32_bf16 v[20:23], v[68:71], v[84:87], v[20:23]
    ds_read_b64_tr_b16 v[100:101], v201 offset:8192
    v_lshlrev_b32 v172, 16, v222
    v_and_b32 v173, 0xffff0000, v222
    v_mfma_f32_16x16x32_bf16 v[16:19], v[68:71], v[80:83], v[16:19]
    ds_read_b64_tr_b16 v[102:103], v201 offset:12288
    v_lshlrev_b32 v174, 16, v223
    v_and_b32 v175, 0xffff0000, v223
    s_waitcnt lgkmcnt(10)
    v_mfma_f32_16x16x32_bf16 v[32:35], v[72:75], v[80:83], v[32:35]
    ds_read_b64_tr_b16 v[104:105], v202 offset:8192
    v_lshlrev_b32 v176, 16, v224
    v_and_b32 v177, 0xffff0000, v224
    v_mfma_f32_16x16x32_bf16 v[36:39], v[72:75], v[84:87], v[36:39]
    ds_read_b64_tr_b16 v[106:107], v202 offset:12288
    v_lshlrev_b32 v178, 16, v225
    v_and_b32 v179, 0xffff0000, v225
    v_mfma_f32_16x16x32_bf16 v[40:43], v[72:75], v[88:91], v[40:43]
    ds_read_b64_tr_b16 v[108:109], v203 offset:8192
    v_lshlrev_b32 v180, 16, v226
    v_and_b32 v181, 0xffff0000, v226
    v_mfma_f32_16x16x32_bf16 v[44:47], v[72:75], v[92:95], v[44:47]
    ds_read_b64_tr_b16 v[110:111], v203 offset:12288
    v_lshlrev_b32 v182, 16, v227
    v_and_b32 v183, 0xffff0000, v227
    s_waitcnt lgkmcnt(12)
    v_mfma_f32_16x16x32_bf16 v[60:63], v[76:79], v[92:95], v[60:63]
    v_lshlrev_b32 v184, 16, v228
    v_and_b32 v185, 0xffff0000, v228
    v_mfma_f32_16x16x32_bf16 v[56:59], v[76:79], v[88:91], v[56:59]
    v_lshlrev_b32 v186, 16, v229
    v_and_b32 v187, 0xffff0000, v229
    v_mfma_f32_16x16x32_bf16 v[52:55], v[76:79], v[84:87], v[52:55]
    v_lshlrev_b32 v188, 16, v230
    v_and_b32 v189, 0xffff0000, v230
    v_mfma_f32_16x16x32_bf16 v[48:51], v[76:79], v[80:83], v[48:51]
    v_lshlrev_b32 v190, 16, v231
    v_and_b32 v191, 0xffff0000, v231
    ds_read_b64_tr_b16 v[216:217], v196 offset:0
    ds_read_b64_tr_b16 v[218:219], v196 offset:8
    ds_read_b64_tr_b16 v[220:221], v196 offset:64
    ds_read_b64_tr_b16 v[222:223], v196 offset:72
    ds_read_b64_tr_b16 v[224:225], v196 offset:2048
    ds_read_b64_tr_b16 v[226:227], v196 offset:2056
    ds_read_b64_tr_b16 v[228:229], v196 offset:2112
    ds_read_b64_tr_b16 v[230:231], v196 offset:2120
    s_waitcnt lgkmcnt(14)
    v_swap_b32 v114, v116
    v_swap_b32 v115, v117
    v_swap_b32 v122, v124
    v_swap_b32 v123, v125
    s_barrier
    s_waitcnt lgkmcnt(14)
    v_mfma_f32_16x16x32_bf16 v[0:3], v[96:99], v[112:115], v[0:3]
    ds_read_b128 v[64:67], v204 offset:32768
    v_mfma_f32_16x16x32_bf16 v[4:7], v[96:99], v[116:119], v[4:7]
    ds_read_b128 v[68:71], v204 offset:33792
    v_mfma_f32_16x16x32_bf16 v[8:11], v[96:99], v[120:123], v[8:11]
    ds_read_b128 v[72:75], v204 offset:34816
    v_mfma_f32_16x16x32_bf16 v[12:15], v[96:99], v[124:127], v[12:15]
    ds_read_b128 v[76:79], v204 offset:35840
    s_waitcnt lgkmcnt(15)
    v_mfma_f32_16x16x32_bf16 v[28:31], v[100:103], v[124:127], v[28:31]
    ds_read_b64_tr_b16 v[128:129], v192 offset:32768
    v_mfma_f32_16x16x32_bf16 v[24:27], v[100:103], v[120:123], v[24:27]
    ds_read_b64_tr_b16 v[130:131], v192 offset:34816
    v_mfma_f32_16x16x32_bf16 v[20:23], v[100:103], v[116:119], v[20:23]
    ds_read_b64_tr_b16 v[132:133], v193 offset:32768
    v_mfma_f32_16x16x32_bf16 v[16:19], v[100:103], v[112:115], v[16:19]
    ds_read_b64_tr_b16 v[134:135], v193 offset:34816
    s_waitcnt lgkmcnt(8)
    v_mfma_f32_16x16x32_bf16 v[32:35], v[104:107], v[112:115], v[32:35]
    ds_read_b128 v[80:83], v204 offset:40960
    v_sub_f32 v208, v160, v232
    v_sub_f32 v209, v161, v232
    v_mfma_f32_16x16x32_bf16 v[36:39], v[104:107], v[116:119], v[36:39]
    ds_read_b128 v[84:87], v204 offset:41984
    v_lshlrev_b32 v210, 16, v216
    v_and_b32 v211, 0xffff0000, v216
    v_mfma_f32_16x16x32_bf16 v[40:43], v[104:107], v[120:123], v[40:43]
    ds_read_b128 v[88:91], v204 offset:43008
    v_mul_f32 v208, v208, v233
    v_mul_f32 v209, v209, v233
    v_mfma_f32_16x16x32_bf16 v[44:47], v[104:107], v[124:127], v[44:47]
    ds_read_b128 v[92:95], v204 offset:44032
    v_fmac_f32 v160, v208, v210
    v_fmac_f32 v161, v209, v211
    s_waitcnt lgkmcnt(12)
    v_mfma_f32_16x16x32_bf16 v[60:63], v[108:111], v[124:127], v[60:63]
    ds_read_b64_tr_b16 v[136:137], v192 offset:36864
    v_sub_f32 v212, v162, v232
    v_sub_f32 v213, v163, v232
    v_mfma_f32_16x16x32_bf16 v[56:59], v[108:111], v[120:123], v[56:59]
    ds_read_b64_tr_b16 v[138:139], v192 offset:38912
    v_lshlrev_b32 v214, 16, v217
    v_and_b32 v215, 0xffff0000, v217
    v_mfma_f32_16x16x32_bf16 v[52:55], v[108:111], v[116:119], v[52:55]
    ds_read_b64_tr_b16 v[140:141], v193 offset:36864
    v_mul_f32 v212, v212, v233
    v_mul_f32 v213, v213, v233
    v_mfma_f32_16x16x32_bf16 v[48:51], v[108:111], v[112:115], v[48:51]
    ds_read_b64_tr_b16 v[142:143], v193 offset:38912
    v_fmac_f32 v162, v212, v214
    v_fmac_f32 v163, v213, v215
    v_sub_f32 v208, v164, v234
    v_sub_f32 v209, v165, v234
    v_lshlrev_b32 v210, 16, v218
    v_and_b32 v211, 0xffff0000, v218
    v_mul_f32 v208, v208, v235
    v_mul_f32 v209, v209, v235
    s_nop 1
    v_cvt_pk_bf16_f32 v32, v32, v33
    v_cvt_pk_bf16_f32 v33, v34, v35
    v_cvt_pk_bf16_f32 v34, v36, v37
    v_cvt_pk_bf16_f32 v35, v38, v39
    buffer_store_dwordx4 v[32:35], v207, s[12:15], s66 offen offset:0 sc1
    v_cvt_pk_bf16_f32 v36, v40, v41
    v_cvt_pk_bf16_f32 v37, v42, v43
    v_cvt_pk_bf16_f32 v38, v44, v45
    v_cvt_pk_bf16_f32 v39, v46, v47
    buffer_store_dwordx4 v[36:39], v207, s[12:15], s66 offen offset:1024 sc1
    v_cvt_pk_bf16_f32 v40, v48, v49
    v_cvt_pk_bf16_f32 v41, v50, v51
    v_cvt_pk_bf16_f32 v42, v52, v53
    v_cvt_pk_bf16_f32 v43, v54, v55
    buffer_store_dwordx4 v[40:43], v207, s[12:15], s66 offen offset:2048 sc1
    v_cvt_pk_bf16_f32 v44, v56, v57
    v_cvt_pk_bf16_f32 v45, v58, v59
    v_cvt_pk_bf16_f32 v46, v60, v61
    v_cvt_pk_bf16_f32 v47, v62, v63
    buffer_store_dwordx4 v[44:47], v207, s[12:15], s66 offen offset:3072 sc1
    s_waitcnt lgkmcnt(12)
    v_swap_b32 v66, v68
    v_swap_b32 v67, v69
    v_swap_b32 v74, v76
    v_swap_b32 v75, v77
    s_barrier
    s_waitcnt lgkmcnt(8)
    v_mfma_f32_16x16x32_bf16 v[0:3], v[128:131], v[64:67], v[0:3]
    ds_read_b128 v[96:99], v244 offset:0
    v_fmac_f32 v164, v208, v210
    v_fmac_f32 v165, v209, v211
    v_mfma_f32_16x16x32_bf16 v[4:7], v[128:131], v[68:71], v[4:7]
    ds_read_b128 v[100:103], v244 offset:1024
    v_sub_f32 v212, v166, v234
    v_sub_f32 v213, v167, v234
    s_waitcnt lgkmcnt(6)
    v_mfma_f32_16x16x32_bf16 v[8:11], v[128:131], v[72:75], v[8:11]
    ds_read_b128 v[104:107], v244 offset:2048
    v_swap_b32 v82, v84
    v_mfma_f32_16x16x32_bf16 v[12:15], v[128:131], v[76:79], v[12:15]
    ds_read_b128 v[108:111], v244 offset:3072
    v_swap_b32 v83, v85
    v_mfma_f32_16x16x32_bf16 v[28:31], v[132:135], v[76:79], v[28:31]
    ds_read_b64_tr_b16 v[144:145], v194 offset:0
    v_swap_b32 v90, v92
    v_mfma_f32_16x16x32_bf16 v[24:27], v[132:135], v[72:75], v[24:27]
    ds_read_b64_tr_b16 v[146:147], v194 offset:2048
    v_swap_b32 v91, v93
    v_mfma_f32_16x16x32_bf16 v[20:23], v[132:135], v[68:71], v[20:23]
    ds_read_b64_tr_b16 v[148:149], v195 offset:0
    v_lshlrev_b32 v214, 16, v219
    v_and_b32 v215, 0xffff0000, v219
    v_mfma_f32_16x16x32_bf16 v[16:19], v[132:135], v[64:67], v[16:19]
    ds_read_b64_tr_b16 v[150:151], v195 offset:2048
    v_mul_f32 v212, v212, v235
    v_mul_f32 v213, v213, v235
    s_waitcnt lgkmcnt(8)
    v_mfma_f32_16x16x32_bf16 v[0:3], v[136:139], v[80:83], v[0:3]
    ds_read_b128 v[112:115], v244 offset:8192
    v_fmac_f32 v166, v212, v214
    v_fmac_f32 v167, v213, v215
    v_mfma_f32_16x16x32_bf16 v[4:7], v[136:139], v[84:87], v[4:7]
    ds_read_b128 v[116:119], v244 offset:9216
    v_sub_f32 v208, v168, v236
    v_sub_f32 v209, v169, v236
    v_mfma_f32_16x16x32_bf16 v[8:11], v[136:139], v[88:91], v[8:11]
    ds_read_b128 v[120:123], v244 offset:10240
    v_lshlrev_b32 v210, 16, v220
    v_and_b32 v211, 0xffff0000, v220
    v_mfma_f32_16x16x32_bf16 v[12:15], v[136:139], v[92:95], v[12:15]
    ds_read_b128 v[124:127], v244 offset:11264
    v_mul_f32 v208, v208, v237
    v_mul_f32 v209, v209, v237
    v_mfma_f32_16x16x32_bf16 v[28:31], v[140:143], v[92:95], v[28:31]
    ds_read_b64_tr_b16 v[152:153], v194 offset:4096
    v_fmac_f32 v168, v208, v210
    v_fmac_f32 v169, v209, v211
    v_mfma_f32_16x16x32_bf16 v[24:27], v[140:143], v[88:91], v[24:27]
    ds_read_b64_tr_b16 v[154:155], v194 offset:6144
    v_sub_f32 v212, v170, v236
    v_sub_f32 v213, v171, v236
    v_mfma_f32_16x16x32_bf16 v[20:23], v[140:143], v[84:87], v[20:23]
    ds_read_b64_tr_b16 v[156:157], v195 offset:4096
    v_lshlrev_b32 v214, 16, v221
    v_and_b32 v215, 0xffff0000, v221
    v_mfma_f32_16x16x32_bf16 v[16:19], v[140:143], v[80:83], v[16:19]
    ds_read_b64_tr_b16 v[158:159], v195 offset:6144
    s_waitcnt lgkmcnt(12)
    v_swap_b32 v98, v100
    v_swap_b32 v99, v101
    v_swap_b32 v106, v108
    v_swap_b32 v107, v109
    s_barrier
    s_waitcnt lgkmcnt(8)
    v_mfma_f32_16x16x32_bf16 v[0:3], v[144:147], v[96:99], v[0:3]
    ds_read_b128 v[64:67], v244 offset:32768
    v_mul_f32 v212, v212, v237
    v_mul_f32 v213, v213, v237
    v_mfma_f32_16x16x32_bf16 v[4:7], v[144:147], v[100:103], v[4:7]
    ds_read_b128 v[68:71], v244 offset:33792
    v_fmac_f32 v170, v212, v214
    v_fmac_f32 v171, v213, v215
    s_waitcnt lgkmcnt(6)
    v_mfma_f32_16x16x32_bf16 v[8:11], v[144:147], v[104:107], v[8:11]
    ds_read_b128 v[72:75], v244 offset:34816
    v_swap_b32 v114, v116
    v_mfma_f32_16x16x32_bf16 v[12:15], v[144:147], v[108:111], v[12:15]
    ds_read_b128 v[76:79], v244 offset:35840
    v_swap_b32 v115, v117
    v_mfma_f32_16x16x32_bf16 v[28:31], v[148:151], v[108:111], v[28:31]
    ds_read_b64_tr_b16 v[128:129], v194 offset:32768
    v_swap_b32 v122, v124
    v_mfma_f32_16x16x32_bf16 v[24:27], v[148:151], v[104:107], v[24:27]
    ds_read_b64_tr_b16 v[130:131], v194 offset:34816
    v_swap_b32 v123, v125
    v_mfma_f32_16x16x32_bf16 v[20:23], v[148:151], v[100:103], v[20:23]
    ds_read_b64_tr_b16 v[132:133], v195 offset:32768
    v_sub_f32 v208, v172, v238
    v_sub_f32 v209, v173, v238
    v_mfma_f32_16x16x32_bf16 v[16:19], v[148:151], v[96:99], v[16:19]
    ds_read_b64_tr_b16 v[134:135], v195 offset:34816
    v_lshlrev_b32 v210, 16, v222
    v_and_b32 v211, 0xffff0000, v222
    s_waitcnt lgkmcnt(8)
    v_mfma_f32_16x16x32_bf16 v[0:3], v[152:155], v[112:115], v[0:3]
    ds_read_b128 v[80:83], v244 offset:40960
    v_mul_f32 v208, v208, v239
    v_mul_f32 v209, v209, v239
    v_mfma_f32_16x16x32_bf16 v[4:7], v[152:155], v[116:119], v[4:7]
    ds_read_b128 v[84:87], v244 offset:41984
    v_fmac_f32 v172, v208, v210
    v_fmac_f32 v173, v209, v211
    v_mfma_f32_16x16x32_bf16 v[8:11], v[152:155], v[120:123], v[8:11]
    ds_read_b128 v[88:91], v244 offset:43008
    v_sub_f32 v212, v174, v238
    v_sub_f32 v213, v175, v238
    v_mfma_f32_16x16x32_bf16 v[12:15], v[152:155], v[124:127], v[12:15]
    ds_read_b128 v[92:95], v244 offset:44032
    v_lshlrev_b32 v214, 16, v223
    v_and_b32 v215, 0xffff0000, v223
    v_mfma_f32_16x16x32_bf16 v[28:31], v[156:159], v[124:127], v[28:31]
    ds_read_b64_tr_b16 v[136:137], v194 offset:36864
    v_mul_f32 v212, v212, v239
    v_mul_f32 v213, v213, v239
    v_mfma_f32_16x16x32_bf16 v[24:27], v[156:159], v[120:123], v[24:27]
    ds_read_b64_tr_b16 v[138:139], v194 offset:38912
    v_fmac_f32 v174, v212, v214
    v_fmac_f32 v175, v213, v215
    v_mfma_f32_16x16x32_bf16 v[20:23], v[156:159], v[116:119], v[20:23]
    ds_read_b64_tr_b16 v[140:141], v195 offset:36864
    v_sub_f32 v208, v176, v232
    v_sub_f32 v209, v177, v232
    v_mfma_f32_16x16x32_bf16 v[16:19], v[156:159], v[112:115], v[16:19]
    ds_read_b64_tr_b16 v[142:143], v195 offset:38912
    s_waitcnt lgkmcnt(12)
    v_swap_b32 v66, v68
    v_swap_b32 v67, v69
    v_swap_b32 v74, v76
    v_swap_b32 v75, v77
    s_barrier
    s_waitcnt lgkmcnt(8)
    v_mfma_f32_16x16x32_bf16 v[0:3], v[128:131], v[64:67], v[0:3]
    ds_read_b128 v[96:99], v204 offset:0
    v_lshlrev_b32 v210, 16, v224
    v_and_b32 v211, 0xffff0000, v224
    v_mfma_f32_16x16x32_bf16 v[4:7], v[128:131], v[68:71], v[4:7]
    ds_read_b128 v[100:103], v204 offset:1024
    v_mul_f32 v208, v208, v233
    v_mul_f32 v209, v209, v233
    s_waitcnt lgkmcnt(6)
    v_mfma_f32_16x16x32_bf16 v[8:11], v[128:131], v[72:75], v[8:11]
    ds_read_b128 v[104:107], v204 offset:2048
    v_swap_b32 v82, v84
    v_mfma_f32_16x16x32_bf16 v[12:15], v[128:131], v[76:79], v[12:15]
    ds_read_b128 v[108:111], v204 offset:3072
    v_swap_b32 v83, v85
    v_mfma_f32_16x16x32_bf16 v[28:31], v[132:135], v[76:79], v[28:31]
    ds_read_b64_tr_b16 v[144:145], v192 offset:0
    v_swap_b32 v90, v92
    v_mfma_f32_16x16x32_bf16 v[24:27], v[132:135], v[72:75], v[24:27]
    ds_read_b64_tr_b16 v[146:147], v192 offset:2048
    v_swap_b32 v91, v93
    v_mfma_f32_16x16x32_bf16 v[20:23], v[132:135], v[68:71], v[20:23]
    ds_read_b64_tr_b16 v[148:149], v193 offset:0
    v_fmac_f32 v176, v208, v210
    v_fmac_f32 v177, v209, v211
    v_mfma_f32_16x16x32_bf16 v[16:19], v[132:135], v[64:67], v[16:19]
    ds_read_b64_tr_b16 v[150:151], v193 offset:2048
    v_sub_f32 v212, v178, v232
    v_sub_f32 v213, v179, v232
    s_waitcnt lgkmcnt(8)
    v_mfma_f32_16x16x32_bf16 v[0:3], v[136:139], v[80:83], v[0:3]
    ds_read_b128 v[112:115], v204 offset:8192
    v_lshlrev_b32 v214, 16, v225
    v_and_b32 v215, 0xffff0000, v225
    v_mfma_f32_16x16x32_bf16 v[4:7], v[136:139], v[84:87], v[4:7]
    ds_read_b128 v[116:119], v204 offset:9216
    v_mul_f32 v212, v212, v233
    v_mul_f32 v213, v213, v233
    v_mfma_f32_16x16x32_bf16 v[8:11], v[136:139], v[88:91], v[8:11]
    ds_read_b128 v[120:123], v204 offset:10240
    v_fmac_f32 v178, v212, v214
    v_fmac_f32 v179, v213, v215
    v_mfma_f32_16x16x32_bf16 v[12:15], v[136:139], v[92:95], v[12:15]
    ds_read_b128 v[124:127], v204 offset:11264
    v_sub_f32 v208, v180, v234
    v_sub_f32 v209, v181, v234
    v_mfma_f32_16x16x32_bf16 v[28:31], v[140:143], v[92:95], v[28:31]
    ds_read_b64_tr_b16 v[152:153], v192 offset:4096
    v_lshlrev_b32 v210, 16, v226
    v_and_b32 v211, 0xffff0000, v226
    v_mfma_f32_16x16x32_bf16 v[24:27], v[140:143], v[88:91], v[24:27]
    ds_read_b64_tr_b16 v[154:155], v192 offset:6144
    v_mul_f32 v208, v208, v235
    v_mul_f32 v209, v209, v235
    v_mfma_f32_16x16x32_bf16 v[20:23], v[140:143], v[84:87], v[20:23]
    ds_read_b64_tr_b16 v[156:157], v193 offset:4096
    v_fmac_f32 v180, v208, v210
    v_fmac_f32 v181, v209, v211
    v_mfma_f32_16x16x32_bf16 v[16:19], v[140:143], v[80:83], v[16:19]
    ds_read_b64_tr_b16 v[158:159], v193 offset:6144
    s_waitcnt lgkmcnt(12)
    v_swap_b32 v98, v100
    v_swap_b32 v99, v101
    v_swap_b32 v106, v108
    v_swap_b32 v107, v109
    s_barrier
    s_waitcnt lgkmcnt(8)
    v_mfma_f32_16x16x32_bf16 v[0:3], v[144:147], v[96:99], v[0:3]
    ds_read_b128 v[64:67], v204 offset:32768
    v_sub_f32 v212, v182, v234
    v_sub_f32 v213, v183, v234
    v_mfma_f32_16x16x32_bf16 v[4:7], v[144:147], v[100:103], v[4:7]
    ds_read_b128 v[68:71], v204 offset:33792
    v_lshlrev_b32 v214, 16, v227
    v_and_b32 v215, 0xffff0000, v227
    s_waitcnt lgkmcnt(6)
    v_mfma_f32_16x16x32_bf16 v[8:11], v[144:147], v[104:107], v[8:11]
    ds_read_b128 v[72:75], v204 offset:34816
    v_swap_b32 v114, v116
    v_mfma_f32_16x16x32_bf16 v[12:15], v[144:147], v[108:111], v[12:15]
    ds_read_b128 v[76:79], v204 offset:35840
    v_swap_b32 v115, v117
    v_mfma_f32_16x16x32_bf16 v[28:31], v[148:151], v[108:111], v[28:31]
    ds_read_b64_tr_b16 v[128:129], v192 offset:32768
    v_swap_b32 v122, v124
    v_mfma_f32_16x16x32_bf16 v[24:27], v[148:151], v[104:107], v[24:27]
    ds_read_b64_tr_b16 v[130:131], v192 offset:34816
    v_swap_b32 v123, v125
    v_mfma_f32_16x16x32_bf16 v[20:23], v[148:151], v[100:103], v[20:23]
    ds_read_b64_tr_b16 v[132:133], v193 offset:32768
    v_mul_f32 v212, v212, v235
    v_mul_f32 v213, v213, v235
    v_mfma_f32_16x16x32_bf16 v[16:19], v[148:151], v[96:99], v[16:19]
    ds_read_b64_tr_b16 v[134:135], v193 offset:34816
    v_fmac_f32 v182, v212, v214
    v_fmac_f32 v183, v213, v215
    s_waitcnt lgkmcnt(8)
    v_mfma_f32_16x16x32_bf16 v[0:3], v[152:155], v[112:115], v[0:3]
    ds_read_b128 v[80:83], v204 offset:40960
    v_sub_f32 v208, v184, v236
    v_sub_f32 v209, v185, v236
    v_mfma_f32_16x16x32_bf16 v[4:7], v[152:155], v[116:119], v[4:7]
    ds_read_b128 v[84:87], v204 offset:41984
    v_lshlrev_b32 v210, 16, v228
    v_and_b32 v211, 0xffff0000, v228
    v_mfma_f32_16x16x32_bf16 v[8:11], v[152:155], v[120:123], v[8:11]
    ds_read_b128 v[88:91], v204 offset:43008
    v_mul_f32 v208, v208, v237
    v_mul_f32 v209, v209, v237
    v_mfma_f32_16x16x32_bf16 v[12:15], v[152:155], v[124:127], v[12:15]
    ds_read_b128 v[92:95], v204 offset:44032
    v_fmac_f32 v184, v208, v210
    v_fmac_f32 v185, v209, v211
    v_mfma_f32_16x16x32_bf16 v[28:31], v[156:159], v[124:127], v[28:31]
    ds_read_b64_tr_b16 v[136:137], v192 offset:36864
    v_sub_f32 v212, v186, v236
    v_sub_f32 v213, v187, v236
    v_mfma_f32_16x16x32_bf16 v[24:27], v[156:159], v[120:123], v[24:27]
    ds_read_b64_tr_b16 v[138:139], v192 offset:38912
    v_lshlrev_b32 v214, 16, v229
    v_and_b32 v215, 0xffff0000, v229
    v_mfma_f32_16x16x32_bf16 v[20:23], v[156:159], v[116:119], v[20:23]
    ds_read_b64_tr_b16 v[140:141], v193 offset:36864
    v_mul_f32 v212, v212, v237
    v_mul_f32 v213, v213, v237
    v_mfma_f32_16x16x32_bf16 v[16:19], v[156:159], v[112:115], v[16:19]
    ds_read_b64_tr_b16 v[142:143], v193 offset:38912
    s_waitcnt lgkmcnt(12)
    v_swap_b32 v66, v68
    v_swap_b32 v67, v69
    v_swap_b32 v74, v76
    v_swap_b32 v75, v77
    s_barrier
    s_waitcnt lgkmcnt(8)
    v_mfma_f32_16x16x32_bf16 v[0:3], v[128:131], v[64:67], v[0:3]
    ds_read_b128 v[96:99], v244 offset:0
    v_fmac_f32 v186, v212, v214
    v_fmac_f32 v187, v213, v215
    v_mfma_f32_16x16x32_bf16 v[4:7], v[128:131], v[68:71], v[4:7]
    ds_read_b128 v[100:103], v244 offset:1024
    v_sub_f32 v208, v188, v238
    v_sub_f32 v209, v189, v238
    s_waitcnt lgkmcnt(6)
    v_mfma_f32_16x16x32_bf16 v[8:11], v[128:131], v[72:75], v[8:11]
    ds_read_b128 v[104:107], v244 offset:2048
    v_swap_b32 v82, v84
    v_mfma_f32_16x16x32_bf16 v[12:15], v[128:131], v[76:79], v[12:15]
    ds_read_b128 v[108:111], v244 offset:3072
    v_swap_b32 v83, v85
    v_mfma_f32_16x16x32_bf16 v[28:31], v[132:135], v[76:79], v[28:31]
    ds_read_b64_tr_b16 v[144:145], v194 offset:0
    v_swap_b32 v90, v92
    v_mfma_f32_16x16x32_bf16 v[24:27], v[132:135], v[72:75], v[24:27]
    ds_read_b64_tr_b16 v[146:147], v194 offset:2048
    v_swap_b32 v91, v93
    v_mfma_f32_16x16x32_bf16 v[20:23], v[132:135], v[68:71], v[20:23]
    ds_read_b64_tr_b16 v[148:149], v195 offset:0
    v_lshlrev_b32 v210, 16, v230
    v_and_b32 v211, 0xffff0000, v230
    v_mfma_f32_16x16x32_bf16 v[16:19], v[132:135], v[64:67], v[16:19]
    ds_read_b64_tr_b16 v[150:151], v195 offset:2048
    v_mul_f32 v208, v208, v239
    v_mul_f32 v209, v209, v239
    s_waitcnt lgkmcnt(8)
    v_mfma_f32_16x16x32_bf16 v[0:3], v[136:139], v[80:83], v[0:3]
    ds_read_b128 v[112:115], v244 offset:8192
    v_fmac_f32 v188, v208, v210
    v_fmac_f32 v189, v209, v211
    v_mfma_f32_16x16x32_bf16 v[4:7], v[136:139], v[84:87], v[4:7]
    ds_read_b128 v[116:119], v244 offset:9216
    v_sub_f32 v212, v190, v238
    v_sub_f32 v213, v191, v238
    v_mfma_f32_16x16x32_bf16 v[8:11], v[136:139], v[88:91], v[8:11]
    ds_read_b128 v[120:123], v244 offset:10240
    v_lshlrev_b32 v214, 16, v231
    v_and_b32 v215, 0xffff0000, v231
    v_mfma_f32_16x16x32_bf16 v[12:15], v[136:139], v[92:95], v[12:15]
    ds_read_b128 v[124:127], v244 offset:11264
    v_mul_f32 v212, v212, v239
    v_mul_f32 v213, v213, v239
    v_mfma_f32_16x16x32_bf16 v[28:31], v[140:143], v[92:95], v[28:31]
    ds_read_b64_tr_b16 v[152:153], v194 offset:4096
    v_fmac_f32 v190, v212, v214
    v_fmac_f32 v191, v213, v215
    v_mfma_f32_16x16x32_bf16 v[24:27], v[140:143], v[88:91], v[24:27]
    ds_read_b64_tr_b16 v[154:155], v194 offset:6144
    v_mfma_f32_16x16x32_bf16 v[20:23], v[140:143], v[84:87], v[20:23]
    ds_read_b64_tr_b16 v[156:157], v195 offset:4096
    v_mfma_f32_16x16x32_bf16 v[16:19], v[140:143], v[80:83], v[16:19]
    ds_read_b64_tr_b16 v[158:159], v195 offset:6144
    s_waitcnt lgkmcnt(12)
    v_swap_b32 v98, v100
    v_swap_b32 v99, v101
    v_swap_b32 v106, v108
    v_swap_b32 v107, v109
    s_waitcnt lgkmcnt(8)
    v_mfma_f32_16x16x32_bf16 v[0:3], v[144:147], v[96:99], v[0:3]
    v_mfma_f32_16x16x32_bf16 v[4:7], v[144:147], v[100:103], v[4:7]
    s_waitcnt lgkmcnt(4)
    v_mfma_f32_16x16x32_bf16 v[8:11], v[144:147], v[104:107], v[8:11]
    v_swap_b32 v114, v116
    v_mfma_f32_16x16x32_bf16 v[12:15], v[144:147], v[108:111], v[12:15]
    v_swap_b32 v115, v117
    v_mfma_f32_16x16x32_bf16 v[28:31], v[148:151], v[108:111], v[28:31]
    v_swap_b32 v122, v124
    v_mfma_f32_16x16x32_bf16 v[24:27], v[148:151], v[104:107], v[24:27]
    v_swap_b32 v123, v125
    v_mfma_f32_16x16x32_bf16 v[20:23], v[148:151], v[100:103], v[20:23]
    v_mfma_f32_16x16x32_bf16 v[16:19], v[148:151], v[96:99], v[16:19]
    s_waitcnt lgkmcnt(0)
    v_mfma_f32_16x16x32_bf16 v[0:3], v[152:155], v[112:115], v[0:3]
    v_mfma_f32_16x16x32_bf16 v[4:7], v[152:155], v[116:119], v[4:7]
    v_mfma_f32_16x16x32_bf16 v[8:11], v[152:155], v[120:123], v[8:11]
    v_mfma_f32_16x16x32_bf16 v[12:15], v[152:155], v[124:127], v[12:15]
    s_barrier
    v_mfma_f32_16x16x32_bf16 v[28:31], v[156:159], v[124:127], v[28:31]
    ds_read_b128 v[32:35], v197 offset:0
    v_mfma_f32_16x16x32_bf16 v[24:27], v[156:159], v[120:123], v[24:27]
    ds_read_b128 v[36:39], v197 offset:1024
    v_mfma_f32_16x16x32_bf16 v[20:23], v[156:159], v[116:119], v[20:23]
    ds_read_b128 v[40:43], v197 offset:2048
    v_mfma_f32_16x16x32_bf16 v[16:19], v[156:159], v[112:115], v[16:19]
    ds_read_b128 v[44:47], v197 offset:3072
    s_nop 3
    v_pk_add_f32 v[0:1], v[0:1], v[160:161]
    v_pk_add_f32 v[2:3], v[2:3], v[162:163]
    v_pk_add_f32 v[4:5], v[4:5], v[164:165]
    v_pk_add_f32 v[6:7], v[6:7], v[166:167]
    v_pk_add_f32 v[8:9], v[8:9], v[168:169]
    v_pk_add_f32 v[10:11], v[10:11], v[170:171]
    v_pk_add_f32 v[12:13], v[12:13], v[172:173]
    v_pk_add_f32 v[14:15], v[14:15], v[174:175]
    v_pk_add_f32 v[16:17], v[16:17], v[176:177]
    v_pk_add_f32 v[18:19], v[18:19], v[178:179]
    v_pk_add_f32 v[20:21], v[20:21], v[180:181]
    v_pk_add_f32 v[22:23], v[22:23], v[182:183]
    v_pk_add_f32 v[24:25], v[24:25], v[184:185]
    v_pk_add_f32 v[26:27], v[26:27], v[186:187]
    v_pk_add_f32 v[28:29], v[28:29], v[188:189]
    v_pk_add_f32 v[30:31], v[30:31], v[190:191]
    s_waitcnt lgkmcnt(0)
    v_max3_u32 v56, v32, v33, v34
    v_max3_u32 v57, v35, v36, v37
    v_max3_u32 v58, v38, v39, v40
    v_max3_u32 v59, v41, v42, v43
    v_max3_u32 v60, v44, v45, v46
    v_max3_u32 v56, v56, v57, v58
    v_max3_u32 v59, v59, v60, v47
    v_max_u32 v56, v56, v59
    v_cmp_eq_u32 vcc, -1, v56
    s_cbranch_vccz L_rpok_20
    s_mov_b32 s62, 200000
L_rp_19:
    s_sleep 1
    buffer_load_dwordx4 v[32:35], v207, s[12:15], s86 offen offset:0 sc1
    buffer_load_dwordx4 v[36:39], v207, s[12:15], s86 offen offset:1024 sc1
    buffer_load_dwordx4 v[40:43], v207, s[12:15], s86 offen offset:2048 sc1
    buffer_load_dwordx4 v[44:47], v207, s[12:15], s86 offen offset:3072 sc1
    s_waitcnt vmcnt(0)
    v_max3_u32 v56, v32, v33, v34
    v_max3_u32 v57, v35, v36, v37
    v_max3_u32 v58, v38, v39, v40
    v_max3_u32 v59, v41, v42, v43
    v_max3_u32 v60, v44, v45, v46
    v_max3_u32 v56, v56, v57, v58
    v_max3_u32 v59, v59, v60, v47
    v_max_u32 v56, v56, v59
    v_cmp_eq_u32 vcc, -1, v56
    s_cbranch_vccz L_rpok_20
    s_sub_u32 s62, s62, 1
    s_cmp_lg_u32 s62, 0
    s_cbranch_scc1 L_rp_19
L_rpok_20:
    v_lshlrev_b32 v60, 16, v32
    v_and_b32 v61, 0xffff0000, v32
    v_pk_add_f32 v[0:1], v[0:1], v[60:61]
    v_cvt_pk_bf16_f32 v80, v0, v1
    v_lshlrev_b32 v62, 16, v33
    v_and_b32 v63, 0xffff0000, v33
    v_pk_add_f32 v[2:3], v[2:3], v[62:63]
    v_cvt_pk_bf16_f32 v81, v2, v3
    ds_write_b64 v198, v[80:81] offset:0
    v_lshlrev_b32 v60, 16, v34
    v_and_b32 v61, 0xffff0000, v34
    v_pk_add_f32 v[4:5], v[4:5], v[60:61]
    v_cvt_pk_bf16_f32 v82, v4, v5
    v_lshlrev_b32 v62, 16, v35
    v_and_b32 v63, 0xffff0000, v35
    v_pk_add_f32 v[6:7], v[6:7], v[62:63]
    v_cvt_pk_bf16_f32 v83, v6, v7
    ds_write_b64 v198, v[82:83] offset:2304
    v_lshlrev_b32 v60, 16, v36
    v_and_b32 v61, 0xffff0000, v36
    v_pk_add_f32 v[8:9], v[8:9], v[60:61]
    v_cvt_pk_bf16_f32 v84, v8, v9
    v_lshlrev_b32 v62, 16, v37
    v_and_b32 v63, 0xffff0000, v37
    v_pk_add_f32 v[10:11], v[10:11], v[62:63]
    v_cvt_pk_bf16_f32 v85, v10, v11
    ds_write_b64 v198, v[84:85] offset:4608
    v_lshlrev_b32 v60, 16, v38
    v_and_b32 v61, 0xffff0000, v38
    v_pk_add_f32 v[12:13], v[12:13], v[60:61]
    v_cvt_pk_bf16_f32 v86, v12, v13
    v_lshlrev_b32 v62, 16, v39
    v_and_b32 v63, 0xffff0000, v39
    v_pk_add_f32 v[14:15], v[14:15], v[62:63]
    v_cvt_pk_bf16_f32 v87, v14, v15
    ds_write_b64 v198, v[86:87] offset:6912
    v_lshlrev_b32 v60, 16, v40
    v_and_b32 v61, 0xffff0000, v40
    v_pk_add_f32 v[16:17], v[16:17], v[60:61]
    v_cvt_pk_bf16_f32 v88, v16, v17
    v_lshlrev_b32 v62, 16, v41
    v_and_b32 v63, 0xffff0000, v41
    v_pk_add_f32 v[18:19], v[18:19], v[62:63]
    v_cvt_pk_bf16_f32 v89, v18, v19
    ds_write_b64 v198, v[88:89] offset:32
    v_lshlrev_b32 v60, 16, v42
    v_and_b32 v61, 0xffff0000, v42
    v_pk_add_f32 v[20:21], v[20:21], v[60:61]
    v_cvt_pk_bf16_f32 v90, v20, v21
    v_lshlrev_b32 v62, 16, v43
    v_and_b32 v63, 0xffff0000, v43
    v_pk_add_f32 v[22:23], v[22:23], v[62:63]
    v_cvt_pk_bf16_f32 v91, v22, v23
    ds_write_b64 v198, v[90:91] offset:2336
    v_lshlrev_b32 v60, 16, v44
    v_and_b32 v61, 0xffff0000, v44
    v_pk_add_f32 v[24:25], v[24:25], v[60:61]
    v_cvt_pk_bf16_f32 v92, v24, v25
    v_lshlrev_b32 v62, 16, v45
    v_and_b32 v63, 0xffff0000, v45
    v_pk_add_f32 v[26:27], v[26:27], v[62:63]
    v_cvt_pk_bf16_f32 v93, v26, v27
    ds_write_b64 v198, v[92:93] offset:4640
    v_lshlrev_b32 v60, 16, v46
    v_and_b32 v61, 0xffff0000, v46
    v_pk_add_f32 v[28:29], v[28:29], v[60:61]
    v_cvt_pk_bf16_f32 v94, v28, v29
    v_lshlrev_b32 v62, 16, v47
    v_and_b32 v63, 0xffff0000, v47
    v_pk_add_f32 v[30:31], v[30:31], v[62:63]
    v_cvt_pk_bf16_f32 v95, v30, v31
    ds_write_b64 v198, v[94:95] offset:6944
    s_waitcnt lgkmcnt(0)
    s_barrier
    ds_read_b128 v[96:99], v199 offset:0
    ds_read_b128 v[100:103], v199 offset:1152
    ds_read_b128 v[104:107], v199 offset:2304
    ds_read_b128 v[108:111], v199 offset:3456
    s_waitcnt lgkmcnt(3)
    buffer_store_dwordx4 v[96:99], v245, s[20:23], s65 offen nt
    s_add_u32 s65, s65, 16384
    s_waitcnt lgkmcnt(2)
    buffer_store_dwordx4 v[100:103], v245, s[20:23], s65 offen nt
    s_add_u32 s65, s65, 16384
    s_waitcnt lgkmcnt(1)
    buffer_store_dwordx4 v[104:107], v245, s[20:23], s65 offen nt
    s_add_u32 s65, s65, 16384
    s_waitcnt lgkmcnt(0)
    buffer_store_dwordx4 v[108:111], v245, s[20:23], s65 offen nt
    s_add_u32 s65, s65, 16384
    s_endpgm
L_c_cs:
    s_cmp_eq_u32 s74, 15
    s_cbranch_scc1 L_c_last
    s_mov_b32 s68, 15
    v_mfma_f32_16x16x32_bf16 v[216:219], v[112:115], v[244:247], 0
    v_mfma_f32_16x16x32_bf16 v[220:223], v[116:119], v[244:247], 0
    v_mfma_f32_16x16x32_bf16 v[224:227], v[120:123], v[244:247], 0
    v_mfma_f32_16x16x32_bf16 v[228:231], v[124:127], v[244:247], 0
    v_mfma_f32_16x16x32_bf16 v[232:235], v[128:131], v[244:247], 0
    v_mfma_f32_16x16x32_bf16 v[236:239], v[132:135], v[244:247], 0
    v_mfma_f32_16x16x32_bf16 v[240:243], v[136:139], v[244:247], 0
    v_mfma_f32_16x16x32_bf16 v[216:219], v[156:159], v[244:247], v[216:219]
    v_mfma_f32_16x16x32_bf16 v[220:223], v[160:163], v[244:247], v[220:223]
    v_mfma_f32_16x16x32_bf16 v[224:227], v[164:167], v[244:247], v[224:227]
    v_mfma_f32_16x16x32_bf16 v[228:231], v[168:171], v[244:247], v[228:231]
    v_mfma_f32_16x16x32_bf16 v[232:235], v[172:175], v[244:247], v[232:235]
    v_mfma_f32_16x16x32_bf16 v[236:239], v[176:179], v[244:247], v[236:239]
    v_mfma_f32_16x16x32_bf16 v[240:243], v[180:183], v[244:247], v[240:243]
    s_mov_b32 exec_lo, 0x00010001
    s_mov_b32 exec_hi, 0x00010001
    buffer_store_dwordx4 v[216:219], v206, s[16:19], s70 offen offset:0 sc1
    buffer_store_dwordx4 v[220:223], v206, s[16:19], s70 offen offset:64 sc1
    buffer_store_dwordx4 v[224:227], v206, s[16:19], s70 offen offset:128 sc1
    buffer_store_dwordx4 v[228:231], v206, s[16:19], s70 offen offset:192 sc1
    buffer_store_dwordx4 v[232:235], v206, s[16:19], s70 offen offset:256 sc1
    buffer_store_dwordx4 v[236:239], v206, s[16:19], s70 offen offset:320 sc1
    s_nop 1
    buffer_store_dwordx4 v[240:243], v206, s[16:19], s71 offen offset:384 sc1
    s_mov_b64 exec, -1
    s_branch L_c_csback
L_c_fl:
    s_lshl_b32 s63, s5, 8
    s_lshl_b32 s60, s4, 4
    s_add_u32 s63, s63, s60
    s_lshl_b32 s60, s35, 3
    s_add_u32 s63, s63, s60
    s_add_u32 s63, s63, 4096
    s_waitcnt vmcnt(0)
    v_mov_b32 v248, s94
    v_mov_b32 v249, s95
    s_mov_b64 exec, 1
    buffer_store_dwordx2 v[248:249], off, s[28:31], s63 sc1
    s_mov_b64 exec, -1
    s_branch L_c_flback
L_end:
    s_endpgm
    .p2align 6
    .type L_table,@object
L_table:
    .long 0x76543210, 0xfedcba98, 0, 0
    .long 0x76543201, 0xfedcba98, 0, 1
    .long 0x76543102, 0xfedcba98, 0, 2
    .long 0x76542130, 0xfedcba98, 1, 3
    .long 0x76532140, 0xfedcba98, 1, 4
    .long 0x76432150, 0xfedcba98, 1, 5
    .long 0x75432610, 0xfedcba98, 2, 6
    .long 0x65432710, 0xfedcba98, 2, 7
    .long 0x65438210, 0xfedcba97, 3, 8
    .long 0x65439210, 0xfedcba87, 3, 9
    .long 0x6543a210, 0xfedcb987, 3, 10
    .long 0x654b3210, 0xfedca987, 4, 11
    .long 0x654c3210, 0xfedba987, 4, 12
    .long 0x654d3210, 0xfecba987, 4, 13
    .long 0x65e43210, 0xfdcba987, 5, 14
    .long 0x65f43210, 0xedcba987, 5, 15
    .size L_table, 256
.section .rodata,"a"
.p2align 6
.amdhsa_kernel parallel_sum__ssm_conv_h3__dense_activation_silu__prompt_kernel
  .amdhsa_next_free_vgpr 256
  .amdhsa_next_free_sgpr 102
  .amdhsa_accum_offset 256
  .amdhsa_group_segment_fixed_size 0
  .amdhsa_kernarg_size 96
  .amdhsa_user_sgpr_count 2
  .amdhsa_user_sgpr_kernarg_segment_ptr 1
  .amdhsa_system_sgpr_workgroup_id_x 1
  .amdhsa_float_denorm_mode_32 3
.end_amdhsa_kernel
.text
```
